```python
import torch

def _softmax(x, axis=-1):
    return torch.softmax(x, dim=axis)
def _gelu(x):
    return torch.nn.functional.gelu(x, approximate="tanh")
def _silu(x):
    return torch.nn.functional.silu(x)
def _sigmoid(x):
    return torch.sigmoid(x)
def _layernorm(x, axis=-1, eps=1e-5):
    m = x.mean(dim=axis, keepdim=True)
    v = x.var(dim=axis, keepdim=True, unbiased=False)
    return (x - m) / torch.sqrt(v + eps)
def _scatter_add(tgt, idx, src, axis=0):
    return tgt.clone().index_add_(axis, idx, src)
def _segment_sum(src, seg, n):
    out = torch.zeros((n,) + src.shape[1:], dtype=src.dtype)
    return out.index_add_(0, seg, src)
def _pad(x, pw):
    flat = tuple(v for pair in reversed(pw) for v in pair)
    return torch.nn.functional.pad(x, flat)

kernel_name = 'parallel_sum__gqa_block_cached__dense_activation_gelu__decode'

def setup_inputs():

    _w = (lambda a: (lambda t: t.to(torch.bfloat16) if t.is_floating_point() else t)(torch.as_tensor(a)))
    def _A_setup():
        B, Sq, D = 1, 1, 512
        Hq, Hkv, Sk, Dh = 32, 8, 65536, 128
        assert Hq % Hkv == 0, (Hq, Hkv)
        return {
            "x": _w((lambda *s: torch.randn(*s, dtype=torch.bfloat16) * 0.05)(B, Sq, D)),
            "k_cache": _w((lambda *s: torch.randn(*s, dtype=torch.bfloat16) * 3.2)(B, Hkv, Sk, Dh)),
            "v_cache": _w((lambda *s: torch.randn(*s, dtype=torch.bfloat16) * 0.8)(B, Hkv, Sk, Dh)),
            "wq": _w((lambda *s: torch.randn(*s, dtype=torch.bfloat16) * 3.2)(D, Hq * Dh) * (D ** -0.5)),
            "wo": _w((lambda *s: torch.randn(*s, dtype=torch.bfloat16) * 0.8)(Hq * Dh, D) * ((Hq * Dh) ** -0.5)),
        }
    _A_in = _A_setup()

    def _B_setup():
        B, S, D, F = 1, 1, 512, 1792
        return {
            "x": _w((lambda *s: torch.randn(*s, dtype=torch.bfloat16) * 0.05)(B, S, D)),
            "w1": _w((lambda *s: torch.randn(*s, dtype=torch.bfloat16) * 3.2)(D, F) * (D ** -0.5)),
            "b1": _w((lambda *s: torch.randn(*s, dtype=torch.bfloat16) * 3.2)(F) * 0.01),
            "w2": _w((lambda *s: torch.randn(*s, dtype=torch.bfloat16) * 0.4)(F, D) * (F ** -0.5)),
            "b2": _w((lambda *s: torch.randn(*s, dtype=torch.bfloat16) * 0.4)(D) * 0.01),
        }
    _B_in = _B_setup()

    return {
        "A_x": _A_in["x"],
        "A_k_cache": _A_in["k_cache"],
        "A_v_cache": _A_in["v_cache"],
        "A_wq": _A_in["wq"],
        "A_wo": _A_in["wo"],
        "B_x": _B_in["x"],
        "B_w1": _B_in["w1"],
        "B_b1": _B_in["b1"],
        "B_w2": _B_in["w2"],
        "B_b2": _B_in["b2"],
    }

def reference(A_x, A_k_cache, A_v_cache, A_wq, A_wo, B_x, B_w1, B_b1, B_w2, B_b2):
    def _A_ref(x, k_cache, v_cache, wq, wo):
        B, Sq, D = x.shape
        Hq, Dh = 32, 128
        Hkv = k_cache.shape[1]
        rep = Hq // Hkv
        q = (lambda x, *d: x.permute(*d))((x @ wq).reshape(B, Sq, Hq, Dh), 0, 2, 1, 3)
        k = (lambda x, n, axis: torch.repeat_interleave(x, n, dim=axis))(k_cache, rep, axis=1)
        v = (lambda x, n, axis: torch.repeat_interleave(x, n, dim=axis))(v_cache, rep, axis=1)
        scores = torch.einsum("bhqd,bhkd->bhqk", q, k) * (Dh ** -0.5)
        p = _softmax(scores, axis=-1)
        o = torch.einsum("bhqk,bhkd->bhqd", p, v)
        return (lambda x, *d: x.permute(*d))(o, 0, 2, 1, 3).reshape(B, Sq, Hq * Dh) @ wo

    def _B_ref(x, w1, b1, w2, b2):
        h = torch.einsum("bsd,df->bsf", x, w1) + b1
        h = _gelu(h)
        return torch.einsum("bsf,fd->bsd", h, w2) + b2

    x = A_x
    xn = _layernorm(x, axis=-1)
    return x + _A_ref(xn, A_k_cache, A_v_cache, A_wq, A_wo) + _B_ref(xn, B_w1, B_b1, B_w2, B_b2)
```

```asm
; @launch grid=(256,1,1) block=(384,1,1) lds=153728
.amdgcn_target "amdgcn-amd-amdhsa--gfx950"
.text
.globl parallel_sum__gqa_block_cached__dense_activation_gelu__decode_kernel
.p2align 8
.type parallel_sum__gqa_block_cached__dense_activation_gelu__decode_kernel,@function
parallel_sum__gqa_block_cached__dense_activation_gelu__decode_kernel:
    s_load_dwordx16 s[36:51], s[0:1], 0
    s_load_dwordx8 s[52:59], s[0:1], 64
    s_load_dwordx2 s[60:61], s[0:1], 96
    s_cmp_lt_u32 s2, 0x100
    s_cbranch_scc1 L_LIVE
    s_waitcnt lgkmcnt(0)
    s_endpgm
L_LIVE:
    v_lshrrev_b32 v1, 6, v0
    v_and_b32 v0, 63, v0
    s_and_b32 s62, s2, 7
    s_lshr_b32 s63, s2, 3
    v_readfirstlane_b32 s3, v1
    s_mov_b32 s80, 400000
    s_mov_b32 s69, 0x05040100
    s_mov_b32 s70, 0x07060302
    s_cmp_lt_u32 s3, 4
    s_cbranch_scc1 L_STREAM
    s_cmp_eq_u32 s3, 5
    s_cbranch_scc1 L_CTRL
    v_lshlrev_b32 v5, 4, v0
    v_lshrrev_b32 v1, 3, v0
    v_lshlrev_b32 v2, 5, v1
    v_and_b32 v4, 7, v0
    v_lshlrev_b32 v4, 4, v4
    v_lshl_add_u32 v3, v1, 17, v4
    s_add_u32 s33, s62, 1
    s_and_b32 s33, s33, 7
    s_mov_b32 s34, s63
    s_lshr_b32 s83, s34, 3
    s_lshl_b32 s81, s83, 20
    s_lshl_b32 s82, s33, 10
    s_add_u32 s81, s81, s82
    s_and_b32 s82, s34, 7
    s_lshl_b32 s82, s82, 7
    s_add_u32 s81, s81, s82
    s_lshl_b32 s82, s83, 8
    s_waitcnt lgkmcnt(0)
    s_mov_b32 s4, s36
    s_mov_b32 s5, s37
    s_mov_b32 s6, 1024
    s_mov_b32 s7, 0x20000
    s_mov_b32 s16, s42
    s_mov_b32 s17, s43
    s_mov_b32 s18, 4194304
    s_mov_b32 s19, 0x20000
    buffer_load_dwordx4 v[8:11], v5, s[4:7], 0 offen
    buffer_load_dwordx4 v[12:15], v2, s[4:7], s82 offen
    buffer_load_dwordx4 v[16:19], v2, s[4:7], s82 offen offset:16
    s_and_b32 s82, s2, 7
    s_lshl_b32 s82, s82, 7
    v_lshlrev_b32 v2, 4, v1
    buffer_load_dwordx4 v[20:23], v2, s[4:7], s82 offen
    buffer_load_dwordx4 v[32:35], v3, s[16:19], s81 offen nt
    s_addk_i32 s81, 0x2000
    buffer_load_dwordx4 v[36:39], v3, s[16:19], s81 offen nt
    s_addk_i32 s81, 0x2000
    buffer_load_dwordx4 v[40:43], v3, s[16:19], s81 offen nt
    s_addk_i32 s81, 0x2000
    buffer_load_dwordx4 v[44:47], v3, s[16:19], s81 offen nt
    s_addk_i32 s81, 0x2000
    buffer_load_dwordx4 v[48:51], v3, s[16:19], s81 offen nt
    s_addk_i32 s81, 0x2000
    buffer_load_dwordx4 v[52:55], v3, s[16:19], s81 offen nt
    s_addk_i32 s81, 0x2000
    buffer_load_dwordx4 v[56:59], v3, s[16:19], s81 offen nt
    s_addk_i32 s81, 0x2000
    buffer_load_dwordx4 v[60:63], v3, s[16:19], s81 offen nt
    s_addk_i32 s81, 0x2000
    buffer_load_dwordx4 v[64:67], v3, s[16:19], s81 offen nt
    s_addk_i32 s81, 0x2000
    buffer_load_dwordx4 v[68:71], v3, s[16:19], s81 offen nt
    s_addk_i32 s81, 0x2000
    buffer_load_dwordx4 v[72:75], v3, s[16:19], s81 offen nt
    s_addk_i32 s81, 0x2000
    buffer_load_dwordx4 v[76:79], v3, s[16:19], s81 offen nt
    s_addk_i32 s81, 0x2000
    buffer_load_dwordx4 v[80:83], v3, s[16:19], s81 offen nt
    s_addk_i32 s81, 0x2000
    buffer_load_dwordx4 v[84:87], v3, s[16:19], s81 offen nt
    s_addk_i32 s81, 0x2000
    buffer_load_dwordx4 v[88:91], v3, s[16:19], s81 offen nt
    s_addk_i32 s81, 0x2000
    buffer_load_dwordx4 v[92:95], v3, s[16:19], s81 offen nt
    s_branch L_HELP
L_STREAM:
    s_setprio 2
    s_lshl_b32 s81, s62, 24
    s_lshl_b32 s82, s63, 19
    s_add_u32 s81, s81, s82
    s_lshl_b32 s82, s3, 10
    s_add_u32 s81, s81, s82
    v_lshlrev_b32 v2, 4, v0
    v_lshrrev_b32 v7, 4, v0
    v_lshlrev_b32 v14, 6, v7
    v_xor_b32 v1, v14, v2
    v_add_u32 v2, s81, v2
    v_add_u32 v1, s81, v1
    s_mov_b32 s66, 0x7ffff
    s_mul_i32 s64, s2, 16384
    s_and_b32 s64, s64, s66
    s_mov_b32 s65, s64
    s_mul_i32 s68, s3, 37440
    s_waitcnt lgkmcnt(0)
    s_mov_b32 s8, s40
    s_mov_b32 s9, s41
    s_mov_b32 s10, 134217728
    s_mov_b32 s11, 0x20000
    s_mov_b32 s4, s38
    s_mov_b32 s5, s39
    s_mov_b32 s6, 134217728
    s_mov_b32 s7, 0x20000
    s_mov_b32 m0, s68
    s_nop 0
    buffer_load_dwordx4 v1, s[4:7], s64 offen nt lds
    s_addk_i32 s64, 0x1000
    s_and_b32 s64, s64, s66
    s_addk_i32 m0, 1040
    s_nop 0
    buffer_load_dwordx4 v1, s[4:7], s64 offen nt lds
    s_addk_i32 s64, 0x1000
    s_and_b32 s64, s64, s66
    s_addk_i32 m0, 1040
    s_nop 0
    buffer_load_dwordx4 v1, s[4:7], s64 offen nt lds
    s_addk_i32 s64, 0x1000
    s_and_b32 s64, s64, s66
    s_addk_i32 m0, 1040
    s_nop 0
    buffer_load_dwordx4 v1, s[4:7], s64 offen nt lds
    s_addk_i32 s64, 0x1000
    s_and_b32 s64, s64, s66
    s_addk_i32 m0, 1040
    s_nop 0
    buffer_load_dwordx4 v1, s[4:7], s64 offen nt lds
    s_addk_i32 s64, 0x1000
    s_and_b32 s64, s64, s66
    v_and_b32 v14, 3, v0
    v_bfe_u32 v15, v0, 2, 2
    v_mul_u32_u24 v3, 1040, v14
    v_lshl_add_u32 v3, v15, 8, v3
    v_lshl_add_u32 v3, v7, 4, v3
    v_add_u32 v3, s68, v3
    v_xor_b32 v84, 3, v15
    v_lshl_add_u32 v6, v84, 6, v3
    v_xor_b32 v84, 2, v15
    v_lshl_add_u32 v5, v84, 6, v3
    v_xor_b32 v84, 1, v15
    v_lshl_add_u32 v4, v84, 6, v3
    v_xor_b32 v84, 0, v15
    v_lshl_add_u32 v3, v84, 6, v3
    s_addk_i32 m0, 1040
    s_waitcnt vmcnt(4)
    buffer_load_dwordx4 v1, s[4:7], s64 offen nt lds
    s_addk_i32 s64, 0x1000
    s_and_b32 s64, s64, s66
    s_mov_b32 s72, 0x11111111
    s_mov_b32 s73, 0x11111111
    v_cndmask_b32 v8, 0, -1, s[72:73]
    s_mov_b32 s74, 0x22222222
    s_mov_b32 s75, 0x22222222
    v_cndmask_b32 v9, 0, -1, s[74:75]
    s_mov_b32 s76, 0x44444444
    s_mov_b32 s77, 0x44444444
    v_cndmask_b32 v10, 0, -1, s[76:77]
    s_mov_b32 s78, 0x88888888
    s_mov_b32 s79, 0x88888888
    v_cndmask_b32 v11, 0, -1, s[78:79]
    v_mov_b32 v12, 0xff800000
    v_mov_b32 v13, 0
    s_addk_i32 m0, 1040
    s_waitcnt vmcnt(4)
    buffer_load_dwordx4 v1, s[4:7], s64 offen nt lds
    s_addk_i32 s64, 0x1000
    s_and_b32 s64, s64, s66
    s_mov_b32 s12, s60
    s_mov_b32 s13, s61
    s_mov_b32 s14, 4194304
    s_mov_b32 s15, 0x20000
    s_mov_b32 s16, s44
    s_mov_b32 s17, s45
    s_mov_b32 s18, 4194304
    s_mov_b32 s19, 0x20000
    s_mov_b32 s20, s56
    s_mov_b32 s21, s57
    s_mov_b32 s22, 1024
    s_mov_b32 s23, 0x20000
    s_add_u32 s30, s60, 1146880
    s_addc_u32 s31, s61, 0
    s_load_dword s28, s[30:31], 0
    v_lshlrev_b32 v15, 8, v15
    v_lshl_add_u32 v15, v7, 4, v15
    v_add_u32 v15, 149760, v15
    s_lshl_b32 s81, s3, 8
    s_add_u32 s81, s81, 151680
    v_lshl_add_u32 v248, v0, 2, s81
    s_addk_i32 m0, 1040
    s_waitcnt vmcnt(4)
    buffer_load_dwordx4 v1, s[4:7], s64 offen nt lds
    s_addk_i32 s64, 0x1000
    s_and_b32 s64, s64, s66
    s_addk_i32 m0, 1040
    s_waitcnt vmcnt(4)
    buffer_load_dwordx4 v1, s[4:7], s64 offen nt lds
    s_addk_i32 s64, 0x1000
    s_and_b32 s64, s64, s66
    ds_read_b128 v[48:51], v3 offset:0
    ds_read_b128 v[52:55], v4 offset:0
    ds_read_b128 v[56:59], v5 offset:0
    ds_read_b128 v[60:63], v6 offset:0
    s_addk_i32 m0, 1040
    s_waitcnt vmcnt(4)
    buffer_load_dwordx4 v1, s[4:7], s64 offen nt lds
    s_addk_i32 s64, 0x1000
    s_and_b32 s64, s64, s66
    s_addk_i32 m0, 1040
    s_waitcnt vmcnt(4)
    buffer_load_dwordx4 v1, s[4:7], s64 offen nt lds
    s_addk_i32 s64, 0x1000
    s_and_b32 s64, s64, s66
    s_addk_i32 m0, 1040
    s_waitcnt vmcnt(4)
    buffer_load_dwordx4 v1, s[4:7], s64 offen nt lds
    s_addk_i32 s64, 0x1000
    s_and_b32 s64, s64, s66
    s_addk_i32 m0, 1040
    s_waitcnt vmcnt(4)
    buffer_load_dwordx4 v1, s[4:7], s64 offen nt lds
    s_addk_i32 s64, 0x1000
    s_and_b32 s64, s64, s66
    s_addk_i32 m0, 1040
    s_waitcnt vmcnt(4)
    buffer_load_dwordx4 v1, s[4:7], s64 offen nt lds
    s_addk_i32 s64, 0x1000
    s_and_b32 s64, s64, s66
    s_addk_i32 m0, 1040
    s_waitcnt vmcnt(4)
    buffer_load_dwordx4 v1, s[4:7], s64 offen nt lds
    s_addk_i32 s64, 0x1000
    s_and_b32 s64, s64, s66
    s_addk_i32 m0, 1040
    s_waitcnt vmcnt(4)
    buffer_load_dwordx4 v1, s[4:7], s64 offen nt lds
    s_addk_i32 s64, 0x1000
    s_and_b32 s64, s64, s66
    s_addk_i32 m0, 1040
    s_waitcnt vmcnt(4)
    buffer_load_dwordx4 v1, s[4:7], s64 offen nt lds
    s_addk_i32 s64, 0x1000
    s_and_b32 s64, s64, s66
    s_addk_i32 m0, 1040
    s_waitcnt vmcnt(4)
    buffer_load_dwordx4 v1, s[4:7], s64 offen nt lds
    s_addk_i32 s64, 0x1000
    s_and_b32 s64, s64, s66
    s_addk_i32 m0, 1040
    s_waitcnt vmcnt(4)
    buffer_load_dwordx4 v1, s[4:7], s64 offen nt lds
    s_addk_i32 s64, 0x1000
    s_and_b32 s64, s64, s66
    s_addk_i32 m0, 1040
    s_waitcnt vmcnt(4)
    buffer_load_dwordx4 v1, s[4:7], s64 offen nt lds
    s_addk_i32 s64, 0x1000
    s_and_b32 s64, s64, s66
    s_addk_i32 m0, 1040
    s_waitcnt vmcnt(4)
    buffer_load_dwordx4 v1, s[4:7], s64 offen nt lds
    s_addk_i32 s64, 0x1000
    s_and_b32 s64, s64, s66
    s_addk_i32 m0, 1040
    s_waitcnt vmcnt(4)
    buffer_load_dwordx4 v1, s[4:7], s64 offen nt lds
    s_addk_i32 s64, 0x1000
    s_and_b32 s64, s64, s66
    s_addk_i32 m0, 1040
    s_waitcnt vmcnt(4)
    buffer_load_dwordx4 v1, s[4:7], s64 offen nt lds
    s_addk_i32 s64, 0x1000
    s_and_b32 s64, s64, s66
    s_addk_i32 m0, 1040
    s_waitcnt vmcnt(4)
    buffer_load_dwordx4 v1, s[4:7], s64 offen nt lds
    s_addk_i32 s64, 0x1000
    s_and_b32 s64, s64, s66
    s_addk_i32 m0, 1040
    s_waitcnt vmcnt(4)
    buffer_load_dwordx4 v1, s[4:7], s64 offen nt lds
    s_addk_i32 s64, 0x1000
    s_and_b32 s64, s64, s66
    s_addk_i32 m0, 1040
    s_waitcnt vmcnt(4)
    buffer_load_dwordx4 v1, s[4:7], s64 offen nt lds
    s_addk_i32 s64, 0x1000
    s_and_b32 s64, s64, s66
    s_addk_i32 m0, 1040
    s_waitcnt vmcnt(4)
    buffer_load_dwordx4 v1, s[4:7], s64 offen nt lds
    s_addk_i32 s64, 0x1000
    s_and_b32 s64, s64, s66
    s_addk_i32 m0, 1040
    s_waitcnt vmcnt(4)
    buffer_load_dwordx4 v1, s[4:7], s64 offen nt lds
    s_addk_i32 s64, 0x1000
    s_and_b32 s64, s64, s66
    s_addk_i32 m0, 1040
    s_waitcnt vmcnt(4)
    buffer_load_dwordx4 v1, s[4:7], s64 offen nt lds
    s_addk_i32 s64, 0x1000
    s_and_b32 s64, s64, s66
    s_addk_i32 m0, 1040
    s_waitcnt vmcnt(4)
    buffer_load_dwordx4 v1, s[4:7], s64 offen nt lds
    s_addk_i32 s64, 0x1000
    s_and_b32 s64, s64, s66
    s_addk_i32 m0, 1040
    s_waitcnt vmcnt(4)
    buffer_load_dwordx4 v1, s[4:7], s64 offen nt lds
    s_addk_i32 s64, 0x1000
    s_and_b32 s64, s64, s66
    s_addk_i32 m0, 1040
    s_waitcnt vmcnt(4)
    buffer_load_dwordx4 v1, s[4:7], s64 offen nt lds
    s_addk_i32 s64, 0x1000
    s_and_b32 s64, s64, s66
    s_addk_i32 m0, 1040
    s_waitcnt vmcnt(4)
    buffer_load_dwordx4 v1, s[4:7], s64 offen nt lds
    s_addk_i32 s64, 0x1000
    s_and_b32 s64, s64, s66
    s_addk_i32 m0, 1040
    s_waitcnt vmcnt(4)
    buffer_load_dwordx4 v1, s[4:7], s64 offen nt lds
    s_addk_i32 s64, 0x1000
    s_and_b32 s64, s64, s66
    s_addk_i32 m0, 1040
    s_waitcnt vmcnt(4)
    buffer_load_dwordx4 v1, s[4:7], s64 offen nt lds
    s_addk_i32 s64, 0x1000
    s_and_b32 s64, s64, s66
    s_addk_i32 m0, 1040
    s_waitcnt vmcnt(4)
    buffer_load_dwordx4 v1, s[4:7], s64 offen nt lds
    s_addk_i32 s64, 0x1000
    s_and_b32 s64, s64, s66
    s_barrier
    ds_read_b128 v[64:67], v15 offset:0
    ds_read_b128 v[68:71], v15 offset:64
    ds_read_b128 v[72:75], v15 offset:128
    ds_read_b128 v[76:79], v15 offset:192
    s_waitcnt lgkmcnt(0)
    v_mfma_f32_16x16x32_bf16 v[16:19], v[48:51], v[64:67], 0
    v_mfma_f32_16x16x32_bf16 v[16:19], v[52:55], v[68:71], v[16:19]
    v_mfma_f32_16x16x32_bf16 v[16:19], v[56:59], v[72:75], v[16:19]
    v_mfma_f32_16x16x32_bf16 v[16:19], v[60:63], v[76:79], v[16:19]
    ds_read_b128 v[48:51], v3 offset:4160
    ds_read_b128 v[52:55], v4 offset:4160
    ds_read_b128 v[56:59], v5 offset:4160
    ds_read_b128 v[60:63], v6 offset:4160
    s_mov_b32 m0, s68
    v_mov_b32 v249, 36
    ds_write_b32 v248, v249
    ds_read_b32 v250, v248 offset:1024
    s_waitcnt vmcnt(4)
    buffer_load_dwordx4 v1, s[4:7], s64 offen nt lds
    s_addk_i32 s64, 0x1000
    s_and_b32 s64, s64, s66
    s_waitcnt lgkmcnt(0)
    v_mfma_f32_16x16x32_bf16 v[20:23], v[48:51], v[64:67], 0
    v_mfma_f32_16x16x32_bf16 v[20:23], v[52:55], v[68:71], v[20:23]
    v_mfma_f32_16x16x32_bf16 v[20:23], v[56:59], v[72:75], v[20:23]
    v_mfma_f32_16x16x32_bf16 v[20:23], v[60:63], v[76:79], v[20:23]
    ds_read_b128 v[48:51], v3 offset:8320
    ds_read_b128 v[52:55], v4 offset:8320
    ds_read_b128 v[56:59], v5 offset:8320
    ds_read_b128 v[60:63], v6 offset:8320
    s_addk_i32 m0, 1040
    s_waitcnt lgkmcnt(0)
    v_cmp_lt_i32 vcc, v249, v250
    s_waitcnt vmcnt(4)
    buffer_load_dwordx4 v1, s[4:7], s64 offen nt lds
    s_addk_i32 s64, 0x1000
    s_and_b32 s64, s64, s66
    s_waitcnt lgkmcnt(0)
    v_mfma_f32_16x16x32_bf16 v[80:83], v[48:51], v[64:67], 0
    v_mfma_f32_16x16x32_bf16 v[80:83], v[52:55], v[68:71], v[80:83]
    v_mfma_f32_16x16x32_bf16 v[80:83], v[56:59], v[72:75], v[80:83]
    v_mfma_f32_16x16x32_bf16 v[80:83], v[60:63], v[76:79], v[80:83]
    ds_read_b128 v[48:51], v3 offset:12480
    ds_read_b128 v[52:55], v4 offset:12480
    ds_read_b128 v[56:59], v5 offset:12480
    ds_read_b128 v[60:63], v6 offset:12480
    s_addk_i32 m0, 1040
    s_cbranch_vccnz L_F38
    s_waitcnt vmcnt(4)
L_F38:
    buffer_load_dwordx4 v1, s[4:7], s64 offen nt lds
    s_addk_i32 s64, 0x1000
    s_and_b32 s64, s64, s66
    v_cndmask_b32 v16, v16, v80, s[74:75]
    v_cndmask_b32 v17, v17, v81, s[74:75]
    v_cndmask_b32 v18, v18, v82, s[74:75]
    v_cndmask_b32 v19, v19, v83, s[74:75]
    s_waitcnt lgkmcnt(0)
    v_mfma_f32_16x16x32_bf16 v[80:83], v[48:51], v[64:67], 0
    v_mfma_f32_16x16x32_bf16 v[80:83], v[52:55], v[68:71], v[80:83]
    v_mfma_f32_16x16x32_bf16 v[80:83], v[56:59], v[72:75], v[80:83]
    v_mfma_f32_16x16x32_bf16 v[80:83], v[60:63], v[76:79], v[80:83]
    ds_read_b128 v[48:51], v3 offset:16640
    ds_read_b128 v[52:55], v4 offset:16640
    ds_read_b128 v[56:59], v5 offset:16640
    ds_read_b128 v[60:63], v6 offset:16640
    s_addk_i32 m0, 1040
    s_cbranch_vccnz L_F39
    s_waitcnt vmcnt(4)
L_F39:
    buffer_load_dwordx4 v1, s[4:7], s64 offen nt lds
    s_addk_i32 s64, 0x1000
    s_and_b32 s64, s64, s66
    v_cndmask_b32 v20, v20, v80, s[74:75]
    v_cndmask_b32 v21, v21, v81, s[74:75]
    v_cndmask_b32 v22, v22, v82, s[74:75]
    v_cndmask_b32 v23, v23, v83, s[74:75]
    s_waitcnt lgkmcnt(0)
    v_mfma_f32_16x16x32_bf16 v[80:83], v[48:51], v[64:67], 0
    v_mfma_f32_16x16x32_bf16 v[80:83], v[52:55], v[68:71], v[80:83]
    v_mfma_f32_16x16x32_bf16 v[80:83], v[56:59], v[72:75], v[80:83]
    v_mfma_f32_16x16x32_bf16 v[80:83], v[60:63], v[76:79], v[80:83]
    ds_read_b128 v[48:51], v3 offset:20800
    ds_read_b128 v[52:55], v4 offset:20800
    ds_read_b128 v[56:59], v5 offset:20800
    ds_read_b128 v[60:63], v6 offset:20800
    s_addk_i32 m0, 1040
    v_mov_b32 v249, 40
    ds_write_b32 v248, v249
    ds_read_b32 v250, v248 offset:1024
    s_cbranch_vccnz L_F40
    s_waitcnt vmcnt(4)
L_F40:
    s_waitcnt vmcnt(6)
    buffer_load_dwordx4 v1, s[4:7], s64 offen nt lds
    s_addk_i32 s64, 0x1000
    s_and_b32 s64, s64, s66
    v_cndmask_b32 v16, v16, v80, s[76:77]
    v_cndmask_b32 v17, v17, v81, s[76:77]
    v_cndmask_b32 v18, v18, v82, s[76:77]
    v_cndmask_b32 v19, v19, v83, s[76:77]
    s_waitcnt lgkmcnt(0)
    v_mfma_f32_16x16x32_bf16 v[80:83], v[48:51], v[64:67], 0
    v_mfma_f32_16x16x32_bf16 v[80:83], v[52:55], v[68:71], v[80:83]
    v_mfma_f32_16x16x32_bf16 v[80:83], v[56:59], v[72:75], v[80:83]
    v_mfma_f32_16x16x32_bf16 v[80:83], v[60:63], v[76:79], v[80:83]
    ds_read_b128 v[48:51], v3 offset:24960
    ds_read_b128 v[52:55], v4 offset:24960
    ds_read_b128 v[56:59], v5 offset:24960
    ds_read_b128 v[60:63], v6 offset:24960
    s_addk_i32 m0, 1040
    s_waitcnt lgkmcnt(0)
    v_cmp_lt_i32 vcc, v249, v250
    s_cbranch_vccnz L_F41
    s_waitcnt vmcnt(4)
L_F41:
    s_waitcnt vmcnt(6)
    buffer_load_dwordx4 v1, s[4:7], s64 offen nt lds
    s_addk_i32 s64, 0x1000
    s_and_b32 s64, s64, s66
    v_cndmask_b32 v20, v20, v80, s[76:77]
    v_cndmask_b32 v21, v21, v81, s[76:77]
    v_cndmask_b32 v22, v22, v82, s[76:77]
    v_cndmask_b32 v23, v23, v83, s[76:77]
    s_waitcnt lgkmcnt(0)
    v_mfma_f32_16x16x32_bf16 v[80:83], v[48:51], v[64:67], 0
    v_mfma_f32_16x16x32_bf16 v[80:83], v[52:55], v[68:71], v[80:83]
    v_mfma_f32_16x16x32_bf16 v[80:83], v[56:59], v[72:75], v[80:83]
    v_mfma_f32_16x16x32_bf16 v[80:83], v[60:63], v[76:79], v[80:83]
    ds_read_b128 v[48:51], v3 offset:29120
    ds_read_b128 v[52:55], v4 offset:29120
    ds_read_b128 v[56:59], v5 offset:29120
    ds_read_b128 v[60:63], v6 offset:29120
    s_addk_i32 m0, 1040
    s_cbranch_vccnz L_F42
    s_waitcnt vmcnt(4)
L_F42:
    s_waitcnt vmcnt(6)
    buffer_load_dwordx4 v1, s[4:7], s64 offen nt lds
    s_addk_i32 s64, 0x1000
    s_and_b32 s64, s64, s66
    v_cndmask_b32 v16, v16, v80, s[78:79]
    v_cndmask_b32 v17, v17, v81, s[78:79]
    v_cndmask_b32 v18, v18, v82, s[78:79]
    v_cndmask_b32 v19, v19, v83, s[78:79]
    s_waitcnt lgkmcnt(0)
    v_mfma_f32_16x16x32_bf16 v[80:83], v[48:51], v[64:67], 0
    v_mfma_f32_16x16x32_bf16 v[80:83], v[52:55], v[68:71], v[80:83]
    v_mfma_f32_16x16x32_bf16 v[80:83], v[56:59], v[72:75], v[80:83]
    v_mfma_f32_16x16x32_bf16 v[80:83], v[60:63], v[76:79], v[80:83]
    ds_read_b128 v[48:51], v3 offset:33280
    ds_read_b128 v[52:55], v4 offset:33280
    ds_read_b128 v[56:59], v5 offset:33280
    ds_read_b128 v[60:63], v6 offset:33280
    v_cvt_pk_bf16_f32 v84, v16, v17
    v_cvt_pk_bf16_f32 v85, v18, v19
    v_lshlrev_b32 v16, 16, v84
    v_and_b32 v17, 0xffff0000, v84
    v_lshlrev_b32 v18, 16, v85
    v_and_b32 v19, 0xffff0000, v85
    v_mul_f32 v16, 0x3db504f3, v16
    v_mul_f32 v17, 0x3db504f3, v17
    v_mul_f32 v18, 0x3db504f3, v18
    v_mul_f32 v19, 0x3db504f3, v19
    v_cvt_pk_bf16_f32 v84, v16, v17
    v_cvt_pk_bf16_f32 v85, v18, v19
    v_lshlrev_b32 v16, 16, v84
    v_and_b32 v17, 0xffff0000, v84
    v_lshlrev_b32 v18, 16, v85
    v_and_b32 v19, 0xffff0000, v85
    v_max3_f32 v12, v12, v16, v17
    v_max3_f32 v12, v12, v18, v19
    s_addk_i32 m0, 1040
    s_cbranch_vccnz L_F43
    s_waitcnt vmcnt(4)
L_F43:
    s_waitcnt vmcnt(6)
    buffer_load_dwordx4 v1, s[4:7], s64 offen nt lds
    s_addk_i32 s64, 0x1000
    s_and_b32 s64, s64, s66
    v_cndmask_b32 v20, v20, v80, s[78:79]
    v_cndmask_b32 v21, v21, v81, s[78:79]
    v_cndmask_b32 v22, v22, v82, s[78:79]
    v_cndmask_b32 v23, v23, v83, s[78:79]
    s_waitcnt lgkmcnt(0)
    v_mfma_f32_16x16x32_bf16 v[24:27], v[48:51], v[64:67], 0
    v_mfma_f32_16x16x32_bf16 v[24:27], v[52:55], v[68:71], v[24:27]
    v_mfma_f32_16x16x32_bf16 v[24:27], v[56:59], v[72:75], v[24:27]
    v_mfma_f32_16x16x32_bf16 v[24:27], v[60:63], v[76:79], v[24:27]
    v_cvt_pk_bf16_f32 v84, v20, v21
    v_cvt_pk_bf16_f32 v85, v22, v23
    v_lshlrev_b32 v20, 16, v84
    v_and_b32 v21, 0xffff0000, v84
    v_lshlrev_b32 v22, 16, v85
    v_and_b32 v23, 0xffff0000, v85
    v_mul_f32 v20, 0x3db504f3, v20
    v_mul_f32 v21, 0x3db504f3, v21
    v_mul_f32 v22, 0x3db504f3, v22
    v_mul_f32 v23, 0x3db504f3, v23
    v_cvt_pk_bf16_f32 v84, v20, v21
    v_cvt_pk_bf16_f32 v85, v22, v23
    v_lshlrev_b32 v20, 16, v84
    v_and_b32 v21, 0xffff0000, v84
    v_lshlrev_b32 v22, 16, v85
    v_and_b32 v23, 0xffff0000, v85
    v_max3_f32 v12, v12, v20, v21
    v_max3_f32 v12, v12, v22, v23
    s_addk_i32 m0, 1040
    v_mov_b32 v249, 44
    ds_write_b32 v248, v249
    ds_read_b32 v250, v248 offset:1024
    s_cbranch_vccnz L_F44
    s_waitcnt vmcnt(4)
L_F44:
    s_waitcnt vmcnt(6)
    buffer_load_dwordx4 v1, s[4:7], s64 offen nt lds
    s_addk_i32 s64, 0x1000
    s_and_b32 s64, s64, s66
    s_addk_i32 m0, 1040
    s_waitcnt lgkmcnt(0)
    v_cmp_lt_i32 vcc, v249, v250
    s_cbranch_vccnz L_F45
    s_waitcnt vmcnt(4)
L_F45:
    s_waitcnt vmcnt(6)
    buffer_load_dwordx4 v1, s[4:7], s64 offen nt lds
    s_addk_i32 s64, 0x1000
    s_and_b32 s64, s64, s66
    s_addk_i32 m0, 1040
    s_cbranch_vccnz L_F46
    s_waitcnt vmcnt(4)
L_F46:
    s_waitcnt vmcnt(6)
    buffer_load_dwordx4 v1, s[4:7], s64 offen nt lds
    s_addk_i32 s64, 0x1000
    s_and_b32 s64, s64, s66
    ds_read_b128 v[48:51], v3 offset:0
    ds_read_b128 v[52:55], v4 offset:0
    ds_read_b128 v[56:59], v5 offset:0
    ds_read_b128 v[60:63], v6 offset:0
    s_addk_i32 m0, 1040
    s_cbranch_vccnz L_F47
    s_waitcnt vmcnt(4)
L_F47:
    s_waitcnt vmcnt(6)
    buffer_load_dwordx4 v1, s[4:7], s64 offen nt lds
    s_addk_i32 s64, 0x1000
    s_and_b32 s64, s64, s66
    s_waitcnt lgkmcnt(0)
    v_mfma_f32_16x16x32_bf16 v[28:31], v[48:51], v[64:67], 0
    v_mfma_f32_16x16x32_bf16 v[28:31], v[52:55], v[68:71], v[28:31]
    v_mfma_f32_16x16x32_bf16 v[28:31], v[56:59], v[72:75], v[28:31]
    v_mfma_f32_16x16x32_bf16 v[28:31], v[60:63], v[76:79], v[28:31]
    s_addk_i32 m0, 1040
    v_mov_b32 v249, 48
    ds_write_b32 v248, v249
    ds_read_b32 v250, v248 offset:1024
    s_cbranch_vccnz L_F48
    s_waitcnt vmcnt(4)
L_F48:
    s_waitcnt vmcnt(6)
    buffer_load_dwordx4 v1, s[4:7], s64 offen nt lds
    s_addk_i32 s64, 0x1000
    s_and_b32 s64, s64, s66
    s_addk_i32 m0, 1040
    s_waitcnt lgkmcnt(0)
    v_cmp_lt_i32 vcc, v249, v250
    s_cbranch_vccnz L_F49
    s_waitcnt vmcnt(4)
L_F49:
    s_waitcnt vmcnt(6)
    buffer_load_dwordx4 v1, s[4:7], s64 offen nt lds
    s_addk_i32 s64, 0x1000
    s_and_b32 s64, s64, s66
    s_addk_i32 m0, 1040
    s_cbranch_vccnz L_F50
    s_waitcnt vmcnt(4)
L_F50:
    s_waitcnt vmcnt(6)
    buffer_load_dwordx4 v1, s[4:7], s64 offen nt lds
    s_addk_i32 s64, 0x1000
    s_and_b32 s64, s64, s66
    ds_read_b128 v[48:51], v3 offset:4160
    ds_read_b128 v[52:55], v4 offset:4160
    ds_read_b128 v[56:59], v5 offset:4160
    ds_read_b128 v[60:63], v6 offset:4160
    s_addk_i32 m0, 1040
    s_cbranch_vccnz L_F51
    s_waitcnt vmcnt(4)
L_F51:
    s_waitcnt vmcnt(6)
    buffer_load_dwordx4 v1, s[4:7], s64 offen nt lds
    s_addk_i32 s64, 0x1000
    s_and_b32 s64, s64, s66
    s_waitcnt lgkmcnt(0)
    v_mfma_f32_16x16x32_bf16 v[80:83], v[48:51], v[64:67], 0
    v_mfma_f32_16x16x32_bf16 v[80:83], v[52:55], v[68:71], v[80:83]
    v_mfma_f32_16x16x32_bf16 v[80:83], v[56:59], v[72:75], v[80:83]
    v_mfma_f32_16x16x32_bf16 v[80:83], v[60:63], v[76:79], v[80:83]
    s_addk_i32 m0, 1040
    v_mov_b32 v249, 52
    ds_write_b32 v248, v249
    ds_read_b32 v250, v248 offset:1024
    s_cbranch_vccnz L_F52
    s_waitcnt vmcnt(4)
L_F52:
    s_waitcnt vmcnt(6)
    buffer_load_dwordx4 v1, s[4:7], s64 offen nt lds
    s_addk_i32 s64, 0x1000
    s_and_b32 s64, s64, s66
    v_cndmask_b32 v24, v24, v80, s[74:75]
    v_cndmask_b32 v25, v25, v81, s[74:75]
    v_cndmask_b32 v26, v26, v82, s[74:75]
    v_cndmask_b32 v27, v27, v83, s[74:75]
    s_addk_i32 m0, 1040
    s_waitcnt lgkmcnt(0)
    v_cmp_lt_i32 vcc, v249, v250
    s_cbranch_vccnz L_F53
    s_waitcnt vmcnt(4)
L_F53:
    s_waitcnt vmcnt(6)
    buffer_load_dwordx4 v1, s[4:7], s64 offen nt lds
    s_addk_i32 s64, 0x1000
    s_and_b32 s64, s64, s66
    s_addk_i32 m0, 1040
    s_cbranch_vccnz L_F54
    s_waitcnt vmcnt(4)
L_F54:
    s_waitcnt vmcnt(6)
    buffer_load_dwordx4 v1, s[4:7], s64 offen nt lds
    s_addk_i32 s64, 0x1000
    s_and_b32 s64, s64, s66
    ds_read_b128 v[48:51], v3 offset:8320
    ds_read_b128 v[52:55], v4 offset:8320
    ds_read_b128 v[56:59], v5 offset:8320
    ds_read_b128 v[60:63], v6 offset:8320
    s_addk_i32 m0, 1040
    s_cbranch_vccnz L_F55
    s_waitcnt vmcnt(4)
L_F55:
    s_waitcnt vmcnt(6)
    buffer_load_dwordx4 v1, s[4:7], s64 offen nt lds
    s_addk_i32 s64, 0x1000
    s_and_b32 s64, s64, s66
    s_waitcnt lgkmcnt(0)
    v_mfma_f32_16x16x32_bf16 v[80:83], v[48:51], v[64:67], 0
    v_mfma_f32_16x16x32_bf16 v[80:83], v[52:55], v[68:71], v[80:83]
    v_mfma_f32_16x16x32_bf16 v[80:83], v[56:59], v[72:75], v[80:83]
    v_mfma_f32_16x16x32_bf16 v[80:83], v[60:63], v[76:79], v[80:83]
    s_addk_i32 m0, 1040
    v_mov_b32 v249, 56
    ds_write_b32 v248, v249
    ds_read_b32 v250, v248 offset:1024
    s_cbranch_vccnz L_F56
    s_waitcnt vmcnt(4)
L_F56:
    s_waitcnt vmcnt(6)
    buffer_load_dwordx4 v1, s[4:7], s64 offen nt lds
    s_addk_i32 s64, 0x1000
    s_and_b32 s64, s64, s66
    v_cndmask_b32 v28, v28, v80, s[74:75]
    v_cndmask_b32 v29, v29, v81, s[74:75]
    v_cndmask_b32 v30, v30, v82, s[74:75]
    v_cndmask_b32 v31, v31, v83, s[74:75]
    s_addk_i32 m0, 1040
    s_waitcnt lgkmcnt(0)
    v_cmp_lt_i32 vcc, v249, v250
    s_cbranch_vccnz L_F57
    s_waitcnt vmcnt(4)
L_F57:
    s_waitcnt vmcnt(6)
    buffer_load_dwordx4 v1, s[4:7], s64 offen nt lds
    s_addk_i32 s64, 0x1000
    s_and_b32 s64, s64, s66
    s_addk_i32 m0, 1040
    s_cbranch_vccnz L_F58
    s_waitcnt vmcnt(4)
L_F58:
    s_waitcnt vmcnt(6)
    buffer_load_dwordx4 v1, s[4:7], s64 offen nt lds
    s_addk_i32 s64, 0x1000
    s_and_b32 s64, s64, s66
    ds_read_b128 v[48:51], v3 offset:12480
    ds_read_b128 v[52:55], v4 offset:12480
    ds_read_b128 v[56:59], v5 offset:12480
    ds_read_b128 v[60:63], v6 offset:12480
    s_addk_i32 m0, 1040
    s_cbranch_vccnz L_F59
    s_waitcnt vmcnt(4)
L_F59:
    s_waitcnt vmcnt(6)
    buffer_load_dwordx4 v1, s[4:7], s64 offen nt lds
    s_addk_i32 s64, 0x1000
    s_and_b32 s64, s64, s66
    s_waitcnt lgkmcnt(0)
    v_mfma_f32_16x16x32_bf16 v[80:83], v[48:51], v[64:67], 0
    v_mfma_f32_16x16x32_bf16 v[80:83], v[52:55], v[68:71], v[80:83]
    v_mfma_f32_16x16x32_bf16 v[80:83], v[56:59], v[72:75], v[80:83]
    v_mfma_f32_16x16x32_bf16 v[80:83], v[60:63], v[76:79], v[80:83]
    s_addk_i32 m0, 1040
    v_mov_b32 v249, 60
    ds_write_b32 v248, v249
    ds_read_b32 v250, v248 offset:1024
    s_cbranch_vccnz L_F60
    s_waitcnt vmcnt(4)
L_F60:
    s_waitcnt vmcnt(6)
    buffer_load_dwordx4 v1, s[4:7], s64 offen nt lds
    s_addk_i32 s64, 0x1000
    s_and_b32 s64, s64, s66
    v_cndmask_b32 v24, v24, v80, s[76:77]
    v_cndmask_b32 v25, v25, v81, s[76:77]
    v_cndmask_b32 v26, v26, v82, s[76:77]
    v_cndmask_b32 v27, v27, v83, s[76:77]
    s_addk_i32 m0, 1040
    s_waitcnt lgkmcnt(0)
    v_cmp_lt_i32 vcc, v249, v250
    s_cbranch_vccnz L_F61
    s_waitcnt vmcnt(4)
L_F61:
    s_waitcnt vmcnt(6)
    buffer_load_dwordx4 v1, s[4:7], s64 offen nt lds
    s_addk_i32 s64, 0x1000
    s_and_b32 s64, s64, s66
    s_addk_i32 m0, 1040
    s_cbranch_vccnz L_F62
    s_waitcnt vmcnt(4)
L_F62:
    s_waitcnt vmcnt(6)
    buffer_load_dwordx4 v1, s[4:7], s64 offen nt lds
    s_addk_i32 s64, 0x1000
    s_and_b32 s64, s64, s66
    ds_read_b128 v[48:51], v3 offset:16640
    ds_read_b128 v[52:55], v4 offset:16640
    ds_read_b128 v[56:59], v5 offset:16640
    ds_read_b128 v[60:63], v6 offset:16640
    s_addk_i32 m0, 1040
    s_cbranch_vccnz L_F63
    s_waitcnt vmcnt(4)
L_F63:
    s_waitcnt vmcnt(6)
    buffer_load_dwordx4 v1, s[4:7], s64 offen nt lds
    s_addk_i32 s64, 0x1000
    s_and_b32 s64, s64, s66
    s_waitcnt lgkmcnt(0)
    v_mfma_f32_16x16x32_bf16 v[80:83], v[48:51], v[64:67], 0
    v_mfma_f32_16x16x32_bf16 v[80:83], v[52:55], v[68:71], v[80:83]
    v_mfma_f32_16x16x32_bf16 v[80:83], v[56:59], v[72:75], v[80:83]
    v_mfma_f32_16x16x32_bf16 v[80:83], v[60:63], v[76:79], v[80:83]
    s_addk_i32 m0, 1040
    v_mov_b32 v249, 64
    ds_write_b32 v248, v249
    ds_read_b32 v250, v248 offset:1024
    s_cbranch_vccnz L_F64
    s_waitcnt vmcnt(4)
L_F64:
    s_waitcnt vmcnt(6)
    buffer_load_dwordx4 v1, s[4:7], s64 offen nt lds
    s_addk_i32 s64, 0x1000
    s_and_b32 s64, s64, s66
    v_cndmask_b32 v28, v28, v80, s[76:77]
    v_cndmask_b32 v29, v29, v81, s[76:77]
    v_cndmask_b32 v30, v30, v82, s[76:77]
    v_cndmask_b32 v31, v31, v83, s[76:77]
    s_addk_i32 m0, 1040
    s_waitcnt lgkmcnt(0)
    v_cmp_lt_i32 vcc, v249, v250
    s_cbranch_vccnz L_F65
    s_waitcnt vmcnt(4)
L_F65:
    s_waitcnt vmcnt(6)
    buffer_load_dwordx4 v1, s[4:7], s64 offen nt lds
    s_addk_i32 s64, 0x1000
    s_and_b32 s64, s64, s66
    s_addk_i32 m0, 1040
    s_cbranch_vccnz L_F66
    s_waitcnt vmcnt(4)
L_F66:
    s_waitcnt vmcnt(6)
    buffer_load_dwordx4 v1, s[4:7], s64 offen nt lds
    s_addk_i32 s64, 0x1000
    s_and_b32 s64, s64, s66
    ds_read_b128 v[48:51], v3 offset:20800
    ds_read_b128 v[52:55], v4 offset:20800
    ds_read_b128 v[56:59], v5 offset:20800
    ds_read_b128 v[60:63], v6 offset:20800
    s_addk_i32 m0, 1040
    s_cbranch_vccnz L_F67
    s_waitcnt vmcnt(4)
L_F67:
    s_waitcnt vmcnt(6)
    buffer_load_dwordx4 v1, s[4:7], s64 offen nt lds
    s_addk_i32 s64, 0x1000
    s_and_b32 s64, s64, s66
    s_waitcnt lgkmcnt(0)
    v_mfma_f32_16x16x32_bf16 v[80:83], v[48:51], v[64:67], 0
    v_mfma_f32_16x16x32_bf16 v[80:83], v[52:55], v[68:71], v[80:83]
    v_mfma_f32_16x16x32_bf16 v[80:83], v[56:59], v[72:75], v[80:83]
    v_mfma_f32_16x16x32_bf16 v[80:83], v[60:63], v[76:79], v[80:83]
    s_addk_i32 m0, 1040
    v_mov_b32 v249, 68
    ds_write_b32 v248, v249
    ds_read_b32 v250, v248 offset:1024
    s_cbranch_vccnz L_F68
    s_waitcnt vmcnt(4)
L_F68:
    s_waitcnt vmcnt(6)
    buffer_load_dwordx4 v1, s[4:7], s64 offen nt lds
    s_addk_i32 s64, 0x1000
    s_and_b32 s64, s64, s66
    v_cndmask_b32 v24, v24, v80, s[78:79]
    v_cndmask_b32 v25, v25, v81, s[78:79]
    v_cndmask_b32 v26, v26, v82, s[78:79]
    v_cndmask_b32 v27, v27, v83, s[78:79]
    v_cvt_pk_bf16_f32 v84, v24, v25
    v_cvt_pk_bf16_f32 v85, v26, v27
    v_lshlrev_b32 v24, 16, v84
    v_and_b32 v25, 0xffff0000, v84
    v_lshlrev_b32 v26, 16, v85
    v_and_b32 v27, 0xffff0000, v85
    v_mul_f32 v24, 0x3db504f3, v24
    v_mul_f32 v25, 0x3db504f3, v25
    v_mul_f32 v26, 0x3db504f3, v26
    v_mul_f32 v27, 0x3db504f3, v27
    v_cvt_pk_bf16_f32 v84, v24, v25
    v_cvt_pk_bf16_f32 v85, v26, v27
    v_lshlrev_b32 v24, 16, v84
    v_and_b32 v25, 0xffff0000, v84
    v_lshlrev_b32 v26, 16, v85
    v_and_b32 v27, 0xffff0000, v85
    v_max3_f32 v12, v12, v24, v25
    v_max3_f32 v12, v12, v26, v27
    s_addk_i32 m0, 1040
    s_waitcnt lgkmcnt(0)
    v_cmp_lt_i32 vcc, v249, v250
    s_cbranch_vccnz L_F69
    s_waitcnt vmcnt(4)
L_F69:
    s_waitcnt vmcnt(6)
    buffer_load_dwordx4 v1, s[4:7], s64 offen nt lds
    s_addk_i32 s64, 0x1000
    s_and_b32 s64, s64, s66
    s_addk_i32 m0, 1040
    s_cbranch_vccnz L_F70
    s_waitcnt vmcnt(4)
L_F70:
    s_waitcnt vmcnt(6)
    buffer_load_dwordx4 v1, s[4:7], s64 offen nt lds
    s_addk_i32 s64, 0x1000
    s_and_b32 s64, s64, s66
    ds_read_b128 v[48:51], v3 offset:24960
    ds_read_b128 v[52:55], v4 offset:24960
    ds_read_b128 v[56:59], v5 offset:24960
    ds_read_b128 v[60:63], v6 offset:24960
    s_addk_i32 m0, 1040
    s_cbranch_vccnz L_F71
    s_waitcnt vmcnt(4)
L_F71:
    s_waitcnt vmcnt(6)
    buffer_load_dwordx4 v1, s[4:7], s64 offen nt lds
    s_addk_i32 s64, 0x1000
    s_and_b32 s64, s64, s66
    s_waitcnt lgkmcnt(0)
    v_mfma_f32_16x16x32_bf16 v[80:83], v[48:51], v[64:67], 0
    v_mfma_f32_16x16x32_bf16 v[80:83], v[52:55], v[68:71], v[80:83]
    v_mfma_f32_16x16x32_bf16 v[80:83], v[56:59], v[72:75], v[80:83]
    v_mfma_f32_16x16x32_bf16 v[80:83], v[60:63], v[76:79], v[80:83]
    s_mov_b32 m0, s68
    v_mov_b32 v249, 72
    ds_write_b32 v248, v249
    ds_read_b32 v250, v248 offset:1024
    s_cbranch_vccnz L_F72
    s_waitcnt vmcnt(4)
L_F72:
    s_waitcnt vmcnt(6)
    buffer_load_dwordx4 v1, s[4:7], s64 offen nt lds
    s_addk_i32 s64, 0x1000
    s_and_b32 s64, s64, s66
    v_cndmask_b32 v28, v28, v80, s[78:79]
    v_cndmask_b32 v29, v29, v81, s[78:79]
    v_cndmask_b32 v30, v30, v82, s[78:79]
    v_cndmask_b32 v31, v31, v83, s[78:79]
    v_cvt_pk_bf16_f32 v84, v28, v29
    v_cvt_pk_bf16_f32 v85, v30, v31
    v_lshlrev_b32 v28, 16, v84
    v_and_b32 v29, 0xffff0000, v84
    v_lshlrev_b32 v30, 16, v85
    v_and_b32 v31, 0xffff0000, v85
    v_mul_f32 v28, 0x3db504f3, v28
    v_mul_f32 v29, 0x3db504f3, v29
    v_mul_f32 v30, 0x3db504f3, v30
    v_mul_f32 v31, 0x3db504f3, v31
    v_cvt_pk_bf16_f32 v84, v28, v29
    v_cvt_pk_bf16_f32 v85, v30, v31
    v_lshlrev_b32 v28, 16, v84
    v_and_b32 v29, 0xffff0000, v84
    v_lshlrev_b32 v30, 16, v85
    v_and_b32 v31, 0xffff0000, v85
    v_max3_f32 v12, v12, v28, v29
    v_max3_f32 v12, v12, v30, v31
    s_addk_i32 m0, 1040
    s_waitcnt lgkmcnt(0)
    v_cmp_lt_i32 vcc, v249, v250
    s_cbranch_vccnz L_F73
    s_waitcnt vmcnt(4)
L_F73:
    s_waitcnt vmcnt(6)
    buffer_load_dwordx4 v1, s[4:7], s64 offen nt lds
    s_addk_i32 s64, 0x1000
    s_and_b32 s64, s64, s66
    s_addk_i32 m0, 1040
    s_cbranch_vccnz L_F74
    s_waitcnt vmcnt(4)
L_F74:
    s_waitcnt vmcnt(6)
    buffer_load_dwordx4 v1, s[4:7], s64 offen nt lds
    s_addk_i32 s64, 0x1000
    s_and_b32 s64, s64, s66
    ds_read_b128 v[48:51], v3 offset:29120
    ds_read_b128 v[52:55], v4 offset:29120
    ds_read_b128 v[56:59], v5 offset:29120
    ds_read_b128 v[60:63], v6 offset:29120
    s_addk_i32 m0, 1040
    s_cbranch_vccnz L_F75
    s_waitcnt vmcnt(4)
L_F75:
    s_waitcnt vmcnt(6)
    buffer_load_dwordx4 v1, s[4:7], s64 offen nt lds
    s_addk_i32 s64, 0x1000
    s_and_b32 s64, s64, s66
    s_waitcnt lgkmcnt(0)
    v_mfma_f32_16x16x32_bf16 v[32:35], v[48:51], v[64:67], 0
    v_mfma_f32_16x16x32_bf16 v[32:35], v[52:55], v[68:71], v[32:35]
    v_mfma_f32_16x16x32_bf16 v[32:35], v[56:59], v[72:75], v[32:35]
    v_mfma_f32_16x16x32_bf16 v[32:35], v[60:63], v[76:79], v[32:35]
    s_addk_i32 m0, 1040
    v_mov_b32 v249, 76
    ds_write_b32 v248, v249
    ds_read_b32 v250, v248 offset:1024
    s_cbranch_vccnz L_F76
    s_waitcnt vmcnt(4)
L_F76:
    s_waitcnt vmcnt(6)
    buffer_load_dwordx4 v1, s[4:7], s64 offen nt lds
    s_addk_i32 s64, 0x1000
    s_and_b32 s64, s64, s66
    s_addk_i32 m0, 1040
    s_waitcnt lgkmcnt(0)
    v_cmp_lt_i32 vcc, v249, v250
    s_cbranch_vccnz L_F77
    s_waitcnt vmcnt(4)
L_F77:
    s_waitcnt vmcnt(6)
    buffer_load_dwordx4 v1, s[4:7], s64 offen nt lds
    s_addk_i32 s64, 0x1000
    s_and_b32 s64, s64, s66
    s_addk_i32 m0, 1040
    s_cbranch_vccnz L_F78
    s_waitcnt vmcnt(4)
L_F78:
    s_waitcnt vmcnt(6)
    buffer_load_dwordx4 v1, s[4:7], s64 offen nt lds
    s_addk_i32 s64, 0x1000
    s_and_b32 s64, s64, s66
    ds_read_b128 v[48:51], v3 offset:33280
    ds_read_b128 v[52:55], v4 offset:33280
    ds_read_b128 v[56:59], v5 offset:33280
    ds_read_b128 v[60:63], v6 offset:33280
    s_addk_i32 m0, 1040
    s_cbranch_vccnz L_F79
    s_waitcnt vmcnt(4)
L_F79:
    s_waitcnt vmcnt(6)
    buffer_load_dwordx4 v1, s[4:7], s64 offen nt lds
    s_addk_i32 s64, 0x1000
    s_and_b32 s64, s64, s66
    s_waitcnt lgkmcnt(0)
    v_mfma_f32_16x16x32_bf16 v[36:39], v[48:51], v[64:67], 0
    v_mfma_f32_16x16x32_bf16 v[36:39], v[52:55], v[68:71], v[36:39]
    v_mfma_f32_16x16x32_bf16 v[36:39], v[56:59], v[72:75], v[36:39]
    v_mfma_f32_16x16x32_bf16 v[36:39], v[60:63], v[76:79], v[36:39]
    s_addk_i32 m0, 1040
    v_mov_b32 v249, 80
    ds_write_b32 v248, v249
    ds_read_b32 v250, v248 offset:1024
    s_cbranch_vccnz L_F80
    s_waitcnt vmcnt(4)
L_F80:
    s_waitcnt vmcnt(6)
    buffer_load_dwordx4 v1, s[4:7], s64 offen nt lds
    s_addk_i32 s64, 0x1000
    s_and_b32 s64, s64, s66
    s_addk_i32 m0, 1040
    s_waitcnt lgkmcnt(0)
    v_cmp_lt_i32 vcc, v249, v250
    s_cbranch_vccnz L_F81
    s_waitcnt vmcnt(4)
L_F81:
    s_waitcnt vmcnt(6)
    buffer_load_dwordx4 v1, s[4:7], s64 offen nt lds
    s_addk_i32 s64, 0x1000
    s_and_b32 s64, s64, s66
    s_addk_i32 m0, 1040
    s_cbranch_vccnz L_F82
    s_waitcnt vmcnt(4)
L_F82:
    s_waitcnt vmcnt(6)
    buffer_load_dwordx4 v1, s[4:7], s64 offen nt lds
    s_addk_i32 s64, 0x1000
    s_and_b32 s64, s64, s66
    ds_read_b128 v[48:51], v3 offset:0
    ds_read_b128 v[52:55], v4 offset:0
    ds_read_b128 v[56:59], v5 offset:0
    ds_read_b128 v[60:63], v6 offset:0
    s_addk_i32 m0, 1040
    s_cbranch_vccnz L_F83
    s_waitcnt vmcnt(4)
L_F83:
    s_waitcnt vmcnt(6)
    buffer_load_dwordx4 v1, s[4:7], s64 offen nt lds
    s_addk_i32 s64, 0x1000
    s_and_b32 s64, s64, s66
    s_waitcnt lgkmcnt(0)
    v_mfma_f32_16x16x32_bf16 v[80:83], v[48:51], v[64:67], 0
    v_mfma_f32_16x16x32_bf16 v[80:83], v[52:55], v[68:71], v[80:83]
    v_mfma_f32_16x16x32_bf16 v[80:83], v[56:59], v[72:75], v[80:83]
    v_mfma_f32_16x16x32_bf16 v[80:83], v[60:63], v[76:79], v[80:83]
    s_addk_i32 m0, 1040
    v_mov_b32 v249, 84
    ds_write_b32 v248, v249
    ds_read_b32 v250, v248 offset:1024
    s_cbranch_vccnz L_F84
    s_waitcnt vmcnt(4)
L_F84:
    s_waitcnt vmcnt(6)
    buffer_load_dwordx4 v1, s[4:7], s64 offen nt lds
    s_addk_i32 s64, 0x1000
    s_and_b32 s64, s64, s66
    v_cndmask_b32 v32, v32, v80, s[74:75]
    v_cndmask_b32 v33, v33, v81, s[74:75]
    v_cndmask_b32 v34, v34, v82, s[74:75]
    v_cndmask_b32 v35, v35, v83, s[74:75]
    s_addk_i32 m0, 1040
    s_waitcnt lgkmcnt(0)
    v_cmp_lt_i32 vcc, v249, v250
    s_cbranch_vccnz L_F85
    s_waitcnt vmcnt(4)
L_F85:
    s_waitcnt vmcnt(6)
    buffer_load_dwordx4 v1, s[4:7], s64 offen nt lds
    s_addk_i32 s64, 0x1000
    s_and_b32 s64, s64, s66
    s_addk_i32 m0, 1040
    s_cbranch_vccnz L_F86
    s_waitcnt vmcnt(4)
L_F86:
    s_waitcnt vmcnt(6)
    buffer_load_dwordx4 v1, s[4:7], s64 offen nt lds
    s_addk_i32 s64, 0x1000
    s_and_b32 s64, s64, s66
    ds_read_b128 v[48:51], v3 offset:4160
    ds_read_b128 v[52:55], v4 offset:4160
    ds_read_b128 v[56:59], v5 offset:4160
    ds_read_b128 v[60:63], v6 offset:4160
    s_addk_i32 m0, 1040
    s_cbranch_vccnz L_F87
    s_waitcnt vmcnt(4)
L_F87:
    s_waitcnt vmcnt(6)
    buffer_load_dwordx4 v1, s[4:7], s64 offen nt lds
    s_addk_i32 s64, 0x1000
    s_and_b32 s64, s64, s66
    s_waitcnt lgkmcnt(0)
    v_mfma_f32_16x16x32_bf16 v[80:83], v[48:51], v[64:67], 0
    v_mfma_f32_16x16x32_bf16 v[80:83], v[52:55], v[68:71], v[80:83]
    v_mfma_f32_16x16x32_bf16 v[80:83], v[56:59], v[72:75], v[80:83]
    v_mfma_f32_16x16x32_bf16 v[80:83], v[60:63], v[76:79], v[80:83]
    s_addk_i32 m0, 1040
    v_mov_b32 v249, 88
    ds_write_b32 v248, v249
    ds_read_b32 v250, v248 offset:1024
    s_cbranch_vccnz L_F88
    s_waitcnt vmcnt(4)
L_F88:
    s_waitcnt vmcnt(6)
    buffer_load_dwordx4 v1, s[4:7], s64 offen nt lds
    s_addk_i32 s64, 0x1000
    s_and_b32 s64, s64, s66
    v_cndmask_b32 v36, v36, v80, s[74:75]
    v_cndmask_b32 v37, v37, v81, s[74:75]
    v_cndmask_b32 v38, v38, v82, s[74:75]
    v_cndmask_b32 v39, v39, v83, s[74:75]
    s_addk_i32 m0, 1040
    s_waitcnt lgkmcnt(0)
    v_cmp_lt_i32 vcc, v249, v250
    s_cbranch_vccnz L_F89
    s_waitcnt vmcnt(4)
L_F89:
    s_waitcnt vmcnt(6)
    buffer_load_dwordx4 v1, s[4:7], s64 offen nt lds
    s_addk_i32 s64, 0x1000
    s_and_b32 s64, s64, s66
    s_addk_i32 m0, 1040
    s_cbranch_vccnz L_F90
    s_waitcnt vmcnt(4)
L_F90:
    s_waitcnt vmcnt(6)
    buffer_load_dwordx4 v1, s[4:7], s64 offen nt lds
    s_addk_i32 s64, 0x1000
    s_and_b32 s64, s64, s66
    ds_read_b128 v[48:51], v3 offset:8320
    ds_read_b128 v[52:55], v4 offset:8320
    ds_read_b128 v[56:59], v5 offset:8320
    ds_read_b128 v[60:63], v6 offset:8320
    s_addk_i32 m0, 1040
    s_cbranch_vccnz L_F91
    s_waitcnt vmcnt(4)
L_F91:
    s_waitcnt vmcnt(6)
    buffer_load_dwordx4 v1, s[4:7], s64 offen nt lds
    s_addk_i32 s64, 0x1000
    s_and_b32 s64, s64, s66
    s_waitcnt lgkmcnt(0)
    v_mfma_f32_16x16x32_bf16 v[80:83], v[48:51], v[64:67], 0
    v_mfma_f32_16x16x32_bf16 v[80:83], v[52:55], v[68:71], v[80:83]
    v_mfma_f32_16x16x32_bf16 v[80:83], v[56:59], v[72:75], v[80:83]
    v_mfma_f32_16x16x32_bf16 v[80:83], v[60:63], v[76:79], v[80:83]
    s_addk_i32 m0, 1040
    v_mov_b32 v249, 92
    ds_write_b32 v248, v249
    ds_read_b32 v250, v248 offset:1024
    s_cbranch_vccnz L_F92
    s_waitcnt vmcnt(4)
L_F92:
    s_waitcnt vmcnt(6)
    buffer_load_dwordx4 v1, s[4:7], s64 offen nt lds
    s_addk_i32 s64, 0x1000
    s_and_b32 s64, s64, s66
    v_cndmask_b32 v32, v32, v80, s[76:77]
    v_cndmask_b32 v33, v33, v81, s[76:77]
    v_cndmask_b32 v34, v34, v82, s[76:77]
    v_cndmask_b32 v35, v35, v83, s[76:77]
    s_addk_i32 m0, 1040
    s_waitcnt lgkmcnt(0)
    v_cmp_lt_i32 vcc, v249, v250
    s_cbranch_vccnz L_F93
    s_waitcnt vmcnt(4)
L_F93:
    s_waitcnt vmcnt(6)
    buffer_load_dwordx4 v1, s[4:7], s64 offen nt lds
    s_addk_i32 s64, 0x1000
    s_and_b32 s64, s64, s66
    s_addk_i32 m0, 1040
    s_cbranch_vccnz L_F94
    s_waitcnt vmcnt(4)
L_F94:
    s_waitcnt vmcnt(6)
    buffer_load_dwordx4 v1, s[4:7], s64 offen nt lds
    s_addk_i32 s64, 0x1000
    s_and_b32 s64, s64, s66
    ds_read_b128 v[48:51], v3 offset:12480
    ds_read_b128 v[52:55], v4 offset:12480
    ds_read_b128 v[56:59], v5 offset:12480
    ds_read_b128 v[60:63], v6 offset:12480
    s_addk_i32 m0, 1040
    s_cbranch_vccnz L_F95
    s_waitcnt vmcnt(4)
L_F95:
    s_waitcnt vmcnt(6)
    buffer_load_dwordx4 v1, s[4:7], s64 offen nt lds
    s_addk_i32 s64, 0x1000
    s_and_b32 s64, s64, s66
    s_waitcnt lgkmcnt(0)
    v_mfma_f32_16x16x32_bf16 v[80:83], v[48:51], v[64:67], 0
    v_mfma_f32_16x16x32_bf16 v[80:83], v[52:55], v[68:71], v[80:83]
    v_mfma_f32_16x16x32_bf16 v[80:83], v[56:59], v[72:75], v[80:83]
    v_mfma_f32_16x16x32_bf16 v[80:83], v[60:63], v[76:79], v[80:83]
    s_addk_i32 m0, 1040
    v_mov_b32 v249, 96
    ds_write_b32 v248, v249
    ds_read_b32 v250, v248 offset:1024
    s_cbranch_vccnz L_F96
    s_waitcnt vmcnt(4)
L_F96:
    s_waitcnt vmcnt(6)
    buffer_load_dwordx4 v1, s[4:7], s64 offen nt lds
    s_addk_i32 s64, 0x1000
    s_and_b32 s64, s64, s66
    v_cndmask_b32 v36, v36, v80, s[76:77]
    v_cndmask_b32 v37, v37, v81, s[76:77]
    v_cndmask_b32 v38, v38, v82, s[76:77]
    v_cndmask_b32 v39, v39, v83, s[76:77]
    s_addk_i32 m0, 1040
    s_waitcnt lgkmcnt(0)
    v_cmp_lt_i32 vcc, v249, v250
    s_cbranch_vccnz L_F97
    s_waitcnt vmcnt(4)
L_F97:
    s_waitcnt vmcnt(6)
    buffer_load_dwordx4 v1, s[4:7], s64 offen nt lds
    s_addk_i32 s64, 0x1000
    s_and_b32 s64, s64, s66
    s_addk_i32 m0, 1040
    s_cbranch_vccnz L_F98
    s_waitcnt vmcnt(4)
L_F98:
    s_waitcnt vmcnt(6)
    buffer_load_dwordx4 v1, s[4:7], s64 offen nt lds
    s_addk_i32 s64, 0x1000
    s_and_b32 s64, s64, s66
    ds_read_b128 v[48:51], v3 offset:16640
    ds_read_b128 v[52:55], v4 offset:16640
    ds_read_b128 v[56:59], v5 offset:16640
    ds_read_b128 v[60:63], v6 offset:16640
    s_addk_i32 m0, 1040
    s_cbranch_vccnz L_F99
    s_waitcnt vmcnt(4)
L_F99:
    s_waitcnt vmcnt(6)
    buffer_load_dwordx4 v1, s[4:7], s64 offen nt lds
    s_addk_i32 s64, 0x1000
    s_and_b32 s64, s64, s66
    s_waitcnt lgkmcnt(0)
    v_mfma_f32_16x16x32_bf16 v[80:83], v[48:51], v[64:67], 0
    v_mfma_f32_16x16x32_bf16 v[80:83], v[52:55], v[68:71], v[80:83]
    v_mfma_f32_16x16x32_bf16 v[80:83], v[56:59], v[72:75], v[80:83]
    v_mfma_f32_16x16x32_bf16 v[80:83], v[60:63], v[76:79], v[80:83]
    s_addk_i32 m0, 1040
    v_mov_b32 v249, 100
    ds_write_b32 v248, v249
    ds_read_b32 v250, v248 offset:1024
    s_cbranch_vccnz L_F100
    s_waitcnt vmcnt(4)
L_F100:
    s_waitcnt vmcnt(6)
    buffer_load_dwordx4 v1, s[4:7], s64 offen nt lds
    s_addk_i32 s64, 0x1000
    s_and_b32 s64, s64, s66
    v_cndmask_b32 v32, v32, v80, s[78:79]
    v_cndmask_b32 v33, v33, v81, s[78:79]
    v_cndmask_b32 v34, v34, v82, s[78:79]
    v_cndmask_b32 v35, v35, v83, s[78:79]
    v_cvt_pk_bf16_f32 v84, v32, v33
    v_cvt_pk_bf16_f32 v85, v34, v35
    v_lshlrev_b32 v32, 16, v84
    v_and_b32 v33, 0xffff0000, v84
    v_lshlrev_b32 v34, 16, v85
    v_and_b32 v35, 0xffff0000, v85
    v_mul_f32 v32, 0x3db504f3, v32
    v_mul_f32 v33, 0x3db504f3, v33
    v_mul_f32 v34, 0x3db504f3, v34
    v_mul_f32 v35, 0x3db504f3, v35
    v_cvt_pk_bf16_f32 v84, v32, v33
    v_cvt_pk_bf16_f32 v85, v34, v35
    v_lshlrev_b32 v32, 16, v84
    v_and_b32 v33, 0xffff0000, v84
    v_lshlrev_b32 v34, 16, v85
    v_and_b32 v35, 0xffff0000, v85
    v_max3_f32 v12, v12, v32, v33
    v_max3_f32 v12, v12, v34, v35
    s_addk_i32 m0, 1040
    s_waitcnt lgkmcnt(0)
    v_cmp_lt_i32 vcc, v249, v250
    s_cbranch_vccnz L_F101
    s_waitcnt vmcnt(4)
L_F101:
    s_waitcnt vmcnt(6)
    buffer_load_dwordx4 v1, s[4:7], s64 offen nt lds
    s_addk_i32 s64, 0x1000
    s_and_b32 s64, s64, s66
    s_addk_i32 m0, 1040
    s_cbranch_vccnz L_F102
    s_waitcnt vmcnt(4)
L_F102:
    s_waitcnt vmcnt(6)
    buffer_load_dwordx4 v1, s[4:7], s64 offen nt lds
    s_addk_i32 s64, 0x1000
    s_and_b32 s64, s64, s66
    ds_read_b128 v[48:51], v3 offset:20800
    ds_read_b128 v[52:55], v4 offset:20800
    ds_read_b128 v[56:59], v5 offset:20800
    ds_read_b128 v[60:63], v6 offset:20800
    s_addk_i32 m0, 1040
    s_cbranch_vccnz L_F103
    s_waitcnt vmcnt(4)
L_F103:
    s_waitcnt vmcnt(6)
    buffer_load_dwordx4 v1, s[4:7], s64 offen nt lds
    s_addk_i32 s64, 0x1000
    s_and_b32 s64, s64, s66
    s_waitcnt lgkmcnt(0)
    v_mfma_f32_16x16x32_bf16 v[80:83], v[48:51], v[64:67], 0
    v_mfma_f32_16x16x32_bf16 v[80:83], v[52:55], v[68:71], v[80:83]
    v_mfma_f32_16x16x32_bf16 v[80:83], v[56:59], v[72:75], v[80:83]
    v_mfma_f32_16x16x32_bf16 v[80:83], v[60:63], v[76:79], v[80:83]
    s_addk_i32 m0, 1040
    v_mov_b32 v249, 104
    ds_write_b32 v248, v249
    ds_read_b32 v250, v248 offset:1024
    s_cbranch_vccnz L_F104
    s_waitcnt vmcnt(4)
L_F104:
    s_waitcnt vmcnt(6)
    buffer_load_dwordx4 v1, s[4:7], s64 offen nt lds
    s_addk_i32 s64, 0x1000
    s_and_b32 s64, s64, s66
    v_cndmask_b32 v36, v36, v80, s[78:79]
    v_cndmask_b32 v37, v37, v81, s[78:79]
    v_cndmask_b32 v38, v38, v82, s[78:79]
    v_cndmask_b32 v39, v39, v83, s[78:79]
    v_cvt_pk_bf16_f32 v84, v36, v37
    v_cvt_pk_bf16_f32 v85, v38, v39
    v_lshlrev_b32 v36, 16, v84
    v_and_b32 v37, 0xffff0000, v84
    v_lshlrev_b32 v38, 16, v85
    v_and_b32 v39, 0xffff0000, v85
    v_mul_f32 v36, 0x3db504f3, v36
    v_mul_f32 v37, 0x3db504f3, v37
    v_mul_f32 v38, 0x3db504f3, v38
    v_mul_f32 v39, 0x3db504f3, v39
    v_cvt_pk_bf16_f32 v84, v36, v37
    v_cvt_pk_bf16_f32 v85, v38, v39
    v_lshlrev_b32 v36, 16, v84
    v_and_b32 v37, 0xffff0000, v84
    v_lshlrev_b32 v38, 16, v85
    v_and_b32 v39, 0xffff0000, v85
    v_max3_f32 v12, v12, v36, v37
    v_max3_f32 v12, v12, v38, v39
    s_addk_i32 m0, 1040
    s_waitcnt lgkmcnt(0)
    v_cmp_lt_i32 vcc, v249, v250
    s_cbranch_vccnz L_F105
    s_waitcnt vmcnt(4)
L_F105:
    s_waitcnt vmcnt(6)
    buffer_load_dwordx4 v1, s[4:7], s64 offen nt lds
    s_addk_i32 s64, 0x1000
    s_and_b32 s64, s64, s66
    s_addk_i32 m0, 1040
    s_cbranch_vccnz L_F106
    s_waitcnt vmcnt(4)
L_F106:
    s_waitcnt vmcnt(6)
    buffer_load_dwordx4 v1, s[4:7], s64 offen nt lds
    s_addk_i32 s64, 0x1000
    s_and_b32 s64, s64, s66
    ds_read_b128 v[48:51], v3 offset:24960
    ds_read_b128 v[52:55], v4 offset:24960
    ds_read_b128 v[56:59], v5 offset:24960
    ds_read_b128 v[60:63], v6 offset:24960
    s_addk_i32 m0, 1040
    s_cbranch_vccnz L_F107
    s_waitcnt vmcnt(4)
L_F107:
    s_waitcnt vmcnt(6)
    buffer_load_dwordx4 v1, s[4:7], s64 offen nt lds
    s_addk_i32 s64, 0x1000
    s_and_b32 s64, s64, s66
    s_waitcnt lgkmcnt(0)
    v_mfma_f32_16x16x32_bf16 v[40:43], v[48:51], v[64:67], 0
    v_mfma_f32_16x16x32_bf16 v[40:43], v[52:55], v[68:71], v[40:43]
    v_mfma_f32_16x16x32_bf16 v[40:43], v[56:59], v[72:75], v[40:43]
    v_mfma_f32_16x16x32_bf16 v[40:43], v[60:63], v[76:79], v[40:43]
    s_mov_b32 m0, s68
    v_mov_b32 v249, 108
    ds_write_b32 v248, v249
    ds_read_b32 v250, v248 offset:1024
    s_cbranch_vccnz L_F108
    s_waitcnt vmcnt(4)
L_F108:
    s_waitcnt vmcnt(6)
    buffer_load_dwordx4 v1, s[4:7], s64 offen nt lds
    s_addk_i32 s64, 0x1000
    s_and_b32 s64, s64, s66
    s_addk_i32 m0, 1040
    s_waitcnt lgkmcnt(0)
    v_cmp_lt_i32 vcc, v249, v250
    s_cbranch_vccnz L_F109
    s_waitcnt vmcnt(4)
L_F109:
    s_waitcnt vmcnt(6)
    buffer_load_dwordx4 v1, s[4:7], s64 offen nt lds
    s_addk_i32 s64, 0x1000
    s_and_b32 s64, s64, s66
    s_addk_i32 m0, 1040
    s_cbranch_vccnz L_F110
    s_waitcnt vmcnt(4)
L_F110:
    s_waitcnt vmcnt(6)
    buffer_load_dwordx4 v1, s[4:7], s64 offen nt lds
    s_addk_i32 s64, 0x1000
    s_and_b32 s64, s64, s66
    ds_read_b128 v[48:51], v3 offset:29120
    ds_read_b128 v[52:55], v4 offset:29120
    ds_read_b128 v[56:59], v5 offset:29120
    ds_read_b128 v[60:63], v6 offset:29120
    s_addk_i32 m0, 1040
    s_cbranch_vccnz L_F111
    s_waitcnt vmcnt(4)
L_F111:
    s_waitcnt vmcnt(6)
    buffer_load_dwordx4 v1, s[4:7], s64 offen nt lds
    s_addk_i32 s64, 0x1000
    s_and_b32 s64, s64, s66
    s_waitcnt lgkmcnt(0)
    v_mfma_f32_16x16x32_bf16 v[44:47], v[48:51], v[64:67], 0
    v_mfma_f32_16x16x32_bf16 v[44:47], v[52:55], v[68:71], v[44:47]
    v_mfma_f32_16x16x32_bf16 v[44:47], v[56:59], v[72:75], v[44:47]
    v_mfma_f32_16x16x32_bf16 v[44:47], v[60:63], v[76:79], v[44:47]
    s_addk_i32 m0, 1040
    v_mov_b32 v249, 112
    ds_write_b32 v248, v249
    ds_read_b32 v250, v248 offset:1024
    s_cbranch_vccnz L_F112
    s_waitcnt vmcnt(4)
L_F112:
    s_waitcnt vmcnt(6)
    buffer_load_dwordx4 v1, s[4:7], s64 offen nt lds
    s_addk_i32 s64, 0x1000
    s_and_b32 s64, s64, s66
    s_addk_i32 m0, 1040
    s_waitcnt lgkmcnt(0)
    v_cmp_lt_i32 vcc, v249, v250
    s_cbranch_vccnz L_F113
    s_waitcnt vmcnt(4)
L_F113:
    s_waitcnt vmcnt(6)
    buffer_load_dwordx4 v1, s[4:7], s64 offen nt lds
    s_addk_i32 s64, 0x1000
    s_and_b32 s64, s64, s66
    s_addk_i32 m0, 1040
    s_cbranch_vccnz L_F114
    s_waitcnt vmcnt(4)
L_F114:
    s_waitcnt vmcnt(6)
    buffer_load_dwordx4 v1, s[4:7], s64 offen nt lds
    s_addk_i32 s64, 0x1000
    s_and_b32 s64, s64, s66
    ds_read_b128 v[48:51], v3 offset:33280
    ds_read_b128 v[52:55], v4 offset:33280
    ds_read_b128 v[56:59], v5 offset:33280
    ds_read_b128 v[60:63], v6 offset:33280
    s_addk_i32 m0, 1040
    s_cbranch_vccnz L_F115
    s_waitcnt vmcnt(4)
L_F115:
    s_waitcnt vmcnt(6)
    buffer_load_dwordx4 v1, s[4:7], s64 offen nt lds
    s_addk_i32 s64, 0x1000
    s_and_b32 s64, s64, s66
    s_waitcnt lgkmcnt(0)
    v_mfma_f32_16x16x32_bf16 v[80:83], v[48:51], v[64:67], 0
    v_mfma_f32_16x16x32_bf16 v[80:83], v[52:55], v[68:71], v[80:83]
    v_mfma_f32_16x16x32_bf16 v[80:83], v[56:59], v[72:75], v[80:83]
    v_mfma_f32_16x16x32_bf16 v[80:83], v[60:63], v[76:79], v[80:83]
    s_addk_i32 m0, 1040
    v_mov_b32 v249, 116
    ds_write_b32 v248, v249
    ds_read_b32 v250, v248 offset:1024
    s_cbranch_vccnz L_F116
    s_waitcnt vmcnt(4)
L_F116:
    s_waitcnt vmcnt(6)
    buffer_load_dwordx4 v1, s[4:7], s64 offen nt lds
    s_addk_i32 s64, 0x1000
    s_and_b32 s64, s64, s66
    v_cndmask_b32 v40, v40, v80, s[74:75]
    v_cndmask_b32 v41, v41, v81, s[74:75]
    v_cndmask_b32 v42, v42, v82, s[74:75]
    v_cndmask_b32 v43, v43, v83, s[74:75]
    s_addk_i32 m0, 1040
    s_waitcnt lgkmcnt(0)
    v_cmp_lt_i32 vcc, v249, v250
    s_cbranch_vccnz L_F117
    s_waitcnt vmcnt(4)
L_F117:
    s_waitcnt vmcnt(6)
    buffer_load_dwordx4 v1, s[4:7], s64 offen nt lds
    s_addk_i32 s64, 0x1000
    s_and_b32 s64, s64, s66
    s_addk_i32 m0, 1040
    s_cbranch_vccnz L_F118
    s_waitcnt vmcnt(4)
L_F118:
    s_waitcnt vmcnt(6)
    buffer_load_dwordx4 v1, s[4:7], s64 offen nt lds
    s_addk_i32 s64, 0x1000
    s_and_b32 s64, s64, s66
    ds_read_b128 v[48:51], v3 offset:0
    ds_read_b128 v[52:55], v4 offset:0
    ds_read_b128 v[56:59], v5 offset:0
    ds_read_b128 v[60:63], v6 offset:0
    s_addk_i32 m0, 1040
    s_cbranch_vccnz L_F119
    s_waitcnt vmcnt(4)
L_F119:
    s_waitcnt vmcnt(6)
    buffer_load_dwordx4 v1, s[4:7], s64 offen nt lds
    s_addk_i32 s64, 0x1000
    s_and_b32 s64, s64, s66
    s_waitcnt lgkmcnt(0)
    v_mfma_f32_16x16x32_bf16 v[80:83], v[48:51], v[64:67], 0
    v_mfma_f32_16x16x32_bf16 v[80:83], v[52:55], v[68:71], v[80:83]
    v_mfma_f32_16x16x32_bf16 v[80:83], v[56:59], v[72:75], v[80:83]
    v_mfma_f32_16x16x32_bf16 v[80:83], v[60:63], v[76:79], v[80:83]
    s_addk_i32 m0, 1040
    v_mov_b32 v249, 120
    ds_write_b32 v248, v249
    ds_read_b32 v250, v248 offset:1024
    s_cbranch_vccnz L_F120
    s_waitcnt vmcnt(4)
L_F120:
    s_waitcnt vmcnt(6)
    buffer_load_dwordx4 v1, s[4:7], s64 offen nt lds
    s_addk_i32 s64, 0x1000
    s_and_b32 s64, s64, s66
    v_cndmask_b32 v44, v44, v80, s[74:75]
    v_cndmask_b32 v45, v45, v81, s[74:75]
    v_cndmask_b32 v46, v46, v82, s[74:75]
    v_cndmask_b32 v47, v47, v83, s[74:75]
    s_addk_i32 m0, 1040
    s_waitcnt lgkmcnt(0)
    v_cmp_lt_i32 vcc, v249, v250
    s_cbranch_vccnz L_F121
    s_waitcnt vmcnt(4)
L_F121:
    s_waitcnt vmcnt(6)
    buffer_load_dwordx4 v1, s[4:7], s64 offen nt lds
    s_addk_i32 s64, 0x1000
    s_and_b32 s64, s64, s66
    s_addk_i32 m0, 1040
    s_cbranch_vccnz L_F122
    s_waitcnt vmcnt(4)
L_F122:
    s_waitcnt vmcnt(6)
    buffer_load_dwordx4 v1, s[4:7], s64 offen nt lds
    s_addk_i32 s64, 0x1000
    s_and_b32 s64, s64, s66
    ds_read_b128 v[48:51], v3 offset:4160
    ds_read_b128 v[52:55], v4 offset:4160
    ds_read_b128 v[56:59], v5 offset:4160
    ds_read_b128 v[60:63], v6 offset:4160
    s_addk_i32 m0, 1040
    s_cbranch_vccnz L_F123
    s_waitcnt vmcnt(4)
L_F123:
    s_waitcnt vmcnt(6)
    buffer_load_dwordx4 v1, s[4:7], s64 offen nt lds
    s_addk_i32 s64, 0x1000
    s_and_b32 s64, s64, s66
    s_waitcnt lgkmcnt(0)
    v_mfma_f32_16x16x32_bf16 v[80:83], v[48:51], v[64:67], 0
    v_mfma_f32_16x16x32_bf16 v[80:83], v[52:55], v[68:71], v[80:83]
    v_mfma_f32_16x16x32_bf16 v[80:83], v[56:59], v[72:75], v[80:83]
    v_mfma_f32_16x16x32_bf16 v[80:83], v[60:63], v[76:79], v[80:83]
    s_addk_i32 m0, 1040
    v_mov_b32 v249, 124
    ds_write_b32 v248, v249
    ds_read_b32 v250, v248 offset:1024
    s_cbranch_vccnz L_F124
    s_waitcnt vmcnt(4)
L_F124:
    s_waitcnt vmcnt(6)
    buffer_load_dwordx4 v1, s[4:7], s64 offen nt lds
    s_addk_i32 s64, 0x1000
    s_and_b32 s64, s64, s66
    v_cndmask_b32 v40, v40, v80, s[76:77]
    v_cndmask_b32 v41, v41, v81, s[76:77]
    v_cndmask_b32 v42, v42, v82, s[76:77]
    v_cndmask_b32 v43, v43, v83, s[76:77]
    s_addk_i32 m0, 1040
    s_waitcnt lgkmcnt(0)
    v_cmp_lt_i32 vcc, v249, v250
    s_cbranch_vccnz L_F125
    s_waitcnt vmcnt(4)
L_F125:
    s_waitcnt vmcnt(6)
    buffer_load_dwordx4 v1, s[4:7], s64 offen nt lds
    s_addk_i32 s64, 0x1000
    s_and_b32 s64, s64, s66
    s_addk_i32 m0, 1040
    s_cbranch_vccnz L_F126
    s_waitcnt vmcnt(4)
L_F126:
    s_waitcnt vmcnt(6)
    buffer_load_dwordx4 v1, s[4:7], s64 offen nt lds
    s_addk_i32 s64, 0x1000
    s_and_b32 s64, s64, s66
    ds_read_b128 v[48:51], v3 offset:8320
    ds_read_b128 v[52:55], v4 offset:8320
    ds_read_b128 v[56:59], v5 offset:8320
    ds_read_b128 v[60:63], v6 offset:8320
    s_addk_i32 m0, 1040
    s_cbranch_vccnz L_F127
    s_waitcnt vmcnt(4)
L_F127:
    s_waitcnt vmcnt(6)
    buffer_load_dwordx4 v1, s[4:7], s64 offen nt lds
    s_addk_i32 s64, 0x1000
    s_and_b32 s64, s64, s66
    s_waitcnt lgkmcnt(0)
    v_mfma_f32_16x16x32_bf16 v[80:83], v[48:51], v[64:67], 0
    v_mfma_f32_16x16x32_bf16 v[80:83], v[52:55], v[68:71], v[80:83]
    v_mfma_f32_16x16x32_bf16 v[80:83], v[56:59], v[72:75], v[80:83]
    v_mfma_f32_16x16x32_bf16 v[80:83], v[60:63], v[76:79], v[80:83]
    v_mov_b32 v249, 128
    ds_write_b32 v248, v249
    ds_read_b32 v250, v248 offset:1024
    s_cbranch_vccnz L_F128
    s_waitcnt vmcnt(4)
L_F128:
    s_waitcnt vmcnt(6)
    buffer_load_dwordx4 v[120:123], v2, s[8:11], s65 offen nt
    s_addk_i32 s65, 0x1000
    s_and_b32 s65, s65, s66
    v_cndmask_b32 v44, v44, v80, s[76:77]
    v_cndmask_b32 v45, v45, v81, s[76:77]
    v_cndmask_b32 v46, v46, v82, s[76:77]
    v_cndmask_b32 v47, v47, v83, s[76:77]
    s_waitcnt lgkmcnt(0)
    v_cmp_lt_i32 vcc, v249, v250
    s_cbranch_vccnz L_F129
    s_waitcnt vmcnt(4)
L_F129:
    s_waitcnt vmcnt(6)
    buffer_load_dwordx4 v[124:127], v2, s[8:11], s65 offen nt
    s_addk_i32 s65, 0x1000
    s_and_b32 s65, s65, s66
    s_cbranch_vccnz L_F130
    s_waitcnt vmcnt(4)
L_F130:
    s_waitcnt vmcnt(6)
    buffer_load_dwordx4 v[128:131], v2, s[8:11], s65 offen nt
    s_addk_i32 s65, 0x1000
    s_and_b32 s65, s65, s66
    ds_read_b128 v[48:51], v3 offset:12480
    ds_read_b128 v[52:55], v4 offset:12480
    ds_read_b128 v[56:59], v5 offset:12480
    ds_read_b128 v[60:63], v6 offset:12480
    s_cbranch_vccnz L_F131
    s_waitcnt vmcnt(4)
L_F131:
    s_waitcnt vmcnt(6)
    buffer_load_dwordx4 v[132:135], v2, s[8:11], s65 offen nt
    s_addk_i32 s65, 0x1000
    s_and_b32 s65, s65, s66
    s_waitcnt lgkmcnt(0)
    v_mfma_f32_16x16x32_bf16 v[80:83], v[48:51], v[64:67], 0
    v_mfma_f32_16x16x32_bf16 v[80:83], v[52:55], v[68:71], v[80:83]
    v_mfma_f32_16x16x32_bf16 v[80:83], v[56:59], v[72:75], v[80:83]
    v_mfma_f32_16x16x32_bf16 v[80:83], v[60:63], v[76:79], v[80:83]
    v_mov_b32 v249, 132
    ds_write_b32 v248, v249
    ds_read_b32 v250, v248 offset:1024
    s_cbranch_vccnz L_F132
    s_waitcnt vmcnt(4)
L_F132:
    s_waitcnt vmcnt(6)
    buffer_load_dwordx4 v[136:139], v2, s[8:11], s65 offen nt
    s_addk_i32 s65, 0x1000
    s_and_b32 s65, s65, s66
    v_cndmask_b32 v40, v40, v80, s[78:79]
    v_cndmask_b32 v41, v41, v81, s[78:79]
    v_cndmask_b32 v42, v42, v82, s[78:79]
    v_cndmask_b32 v43, v43, v83, s[78:79]
    v_cvt_pk_bf16_f32 v84, v40, v41
    v_cvt_pk_bf16_f32 v85, v42, v43
    v_lshlrev_b32 v40, 16, v84
    v_and_b32 v41, 0xffff0000, v84
    v_lshlrev_b32 v42, 16, v85
    v_and_b32 v43, 0xffff0000, v85
    v_mul_f32 v40, 0x3db504f3, v40
    v_mul_f32 v41, 0x3db504f3, v41
    v_mul_f32 v42, 0x3db504f3, v42
    v_mul_f32 v43, 0x3db504f3, v43
    v_cvt_pk_bf16_f32 v84, v40, v41
    v_cvt_pk_bf16_f32 v85, v42, v43
    v_lshlrev_b32 v40, 16, v84
    v_and_b32 v41, 0xffff0000, v84
    v_lshlrev_b32 v42, 16, v85
    v_and_b32 v43, 0xffff0000, v85
    v_max3_f32 v12, v12, v40, v41
    v_max3_f32 v12, v12, v42, v43
    s_waitcnt lgkmcnt(0)
    v_cmp_lt_i32 vcc, v249, v250
    s_cbranch_vccnz L_F133
    s_waitcnt vmcnt(4)
L_F133:
    s_waitcnt vmcnt(6)
    buffer_load_dwordx4 v[140:143], v2, s[8:11], s65 offen nt
    s_addk_i32 s65, 0x1000
    s_and_b32 s65, s65, s66
    s_cbranch_vccnz L_F134
    s_waitcnt vmcnt(4)
L_F134:
    s_waitcnt vmcnt(6)
    buffer_load_dwordx4 v[144:147], v2, s[8:11], s65 offen nt
    s_addk_i32 s65, 0x1000
    s_and_b32 s65, s65, s66
    ds_read_b128 v[48:51], v3 offset:16640
    ds_read_b128 v[52:55], v4 offset:16640
    ds_read_b128 v[56:59], v5 offset:16640
    ds_read_b128 v[60:63], v6 offset:16640
    s_cbranch_vccnz L_F135
    s_waitcnt vmcnt(4)
L_F135:
    s_waitcnt vmcnt(6)
    buffer_load_dwordx4 v[148:151], v2, s[8:11], s65 offen nt
    s_addk_i32 s65, 0x1000
    s_and_b32 s65, s65, s66
    s_waitcnt lgkmcnt(0)
    v_mfma_f32_16x16x32_bf16 v[80:83], v[48:51], v[64:67], 0
    v_mfma_f32_16x16x32_bf16 v[80:83], v[52:55], v[68:71], v[80:83]
    v_mfma_f32_16x16x32_bf16 v[80:83], v[56:59], v[72:75], v[80:83]
    v_mfma_f32_16x16x32_bf16 v[80:83], v[60:63], v[76:79], v[80:83]
    v_mov_b32 v249, 136
    ds_write_b32 v248, v249
    ds_read_b32 v250, v248 offset:1024
    s_cbranch_vccnz L_F136
    s_waitcnt vmcnt(4)
L_F136:
    s_waitcnt vmcnt(6)
    buffer_load_dwordx4 v[152:155], v2, s[8:11], s65 offen nt
    s_addk_i32 s65, 0x1000
    s_and_b32 s65, s65, s66
    v_cndmask_b32 v44, v44, v80, s[78:79]
    v_cndmask_b32 v45, v45, v81, s[78:79]
    v_cndmask_b32 v46, v46, v82, s[78:79]
    v_cndmask_b32 v47, v47, v83, s[78:79]
    v_cvt_pk_bf16_f32 v84, v44, v45
    v_cvt_pk_bf16_f32 v85, v46, v47
    v_lshlrev_b32 v44, 16, v84
    v_and_b32 v45, 0xffff0000, v84
    v_lshlrev_b32 v46, 16, v85
    v_and_b32 v47, 0xffff0000, v85
    v_mul_f32 v44, 0x3db504f3, v44
    v_mul_f32 v45, 0x3db504f3, v45
    v_mul_f32 v46, 0x3db504f3, v46
    v_mul_f32 v47, 0x3db504f3, v47
    v_cvt_pk_bf16_f32 v84, v44, v45
    v_cvt_pk_bf16_f32 v85, v46, v47
    v_lshlrev_b32 v44, 16, v84
    v_and_b32 v45, 0xffff0000, v84
    v_lshlrev_b32 v46, 16, v85
    v_and_b32 v47, 0xffff0000, v85
    v_max3_f32 v12, v12, v44, v45
    v_max3_f32 v12, v12, v46, v47
    v_perm_b32 v88, v124, v120, s69
    v_perm_b32 v92, v124, v120, s70
    v_perm_b32 v96, v125, v121, s69
    v_perm_b32 v100, v125, v121, s70
    v_perm_b32 v104, v126, v122, s69
    v_perm_b32 v108, v126, v122, s70
    v_perm_b32 v112, v127, v123, s69
    v_perm_b32 v116, v127, v123, s70
    v_max_f32_dpp v12, v12, v12 quad_perm:[1,0,3,2] row_mask:0xf bank_mask:0xf
    s_nop 1
    v_max_f32_dpp v12, v12, v12 quad_perm:[2,3,0,1] row_mask:0xf bank_mask:0xf
    v_mov_b32 v84, v12
    s_nop 1
    v_permlane16_swap_b32 v84, v12
    v_max_f32 v12, v84, v12
    v_mov_b32 v84, v12
    s_nop 1
    v_permlane32_swap_b32 v84, v12
    v_max_f32 v12, v84, v12
    v_mov_b32 v64, 0
    v_mov_b32 v65, 0
    v_mov_b32 v66, 0
    v_mov_b32 v67, 0
    v_mov_b32 v68, 0
    v_mov_b32 v69, 0
    v_mov_b32 v70, 0
    v_mov_b32 v71, 0
    s_waitcnt lgkmcnt(0)
    v_cmp_lt_i32 vcc, v249, v250
    s_cbranch_vccnz L_F137
    s_waitcnt vmcnt(4)
L_F137:
    s_waitcnt vmcnt(6)
    buffer_load_dwordx4 v[156:159], v2, s[8:11], s65 offen nt
    s_addk_i32 s65, 0x1000
    s_and_b32 s65, s65, s66
    v_sub_f32 v16, v16, v12
    v_sub_f32 v17, v17, v12
    v_sub_f32 v18, v18, v12
    v_sub_f32 v19, v19, v12
    v_mul_f32 v16, 0x3fb8aa3b, v16
    v_mul_f32 v17, 0x3fb8aa3b, v17
    v_mul_f32 v18, 0x3fb8aa3b, v18
    v_mul_f32 v19, 0x3fb8aa3b, v19
    v_exp_f32 v16, v16
    v_exp_f32 v17, v17
    v_exp_f32 v18, v18
    v_exp_f32 v19, v19
    v_add_f32 v84, v16, v17
    v_add_f32 v85, v18, v19
    v_cvt_pk_bf16_f32 v16, v16, v17
    v_cvt_pk_bf16_f32 v17, v18, v19
    v_add_f32 v13, v13, v84
    v_add_f32 v13, v13, v85
    v_sub_f32 v20, v20, v12
    v_sub_f32 v21, v21, v12
    v_sub_f32 v22, v22, v12
    v_sub_f32 v23, v23, v12
    v_mul_f32 v20, 0x3fb8aa3b, v20
    v_mul_f32 v21, 0x3fb8aa3b, v21
    v_mul_f32 v22, 0x3fb8aa3b, v22
    v_mul_f32 v23, 0x3fb8aa3b, v23
    v_exp_f32 v20, v20
    v_exp_f32 v21, v21
    v_exp_f32 v22, v22
    v_exp_f32 v23, v23
    v_add_f32 v84, v20, v21
    v_add_f32 v85, v22, v23
    v_cvt_pk_bf16_f32 v18, v20, v21
    v_cvt_pk_bf16_f32 v19, v22, v23
    v_add_f32 v13, v13, v84
    v_add_f32 v13, v13, v85
    s_cbranch_vccnz L_F138
    s_waitcnt vmcnt(4)
L_F138:
    s_waitcnt vmcnt(6)
    buffer_load_dwordx4 v[160:163], v2, s[8:11], s65 offen nt
    s_addk_i32 s65, 0x1000
    s_and_b32 s65, s65, s66
    v_and_b32_dpp v48, v16, v8 quad_perm:[0,0,0,0] row_mask:0xf bank_mask:0xf
    v_and_b32_dpp v49, v17, v8 quad_perm:[0,0,0,0] row_mask:0xf bank_mask:0xf
    v_and_b32_dpp v50, v18, v8 quad_perm:[0,0,0,0] row_mask:0xf bank_mask:0xf
    v_and_b32_dpp v51, v19, v8 quad_perm:[0,0,0,0] row_mask:0xf bank_mask:0xf
    v_and_b32_dpp v52, v16, v9 quad_perm:[0,0,0,0] row_mask:0xf bank_mask:0xf
    v_and_b32_dpp v53, v17, v9 quad_perm:[0,0,0,0] row_mask:0xf bank_mask:0xf
    v_and_b32_dpp v54, v18, v9 quad_perm:[0,0,0,0] row_mask:0xf bank_mask:0xf
    v_and_b32_dpp v55, v19, v9 quad_perm:[0,0,0,0] row_mask:0xf bank_mask:0xf
    v_and_b32_dpp v56, v16, v10 quad_perm:[0,0,0,0] row_mask:0xf bank_mask:0xf
    v_and_b32_dpp v57, v17, v10 quad_perm:[0,0,0,0] row_mask:0xf bank_mask:0xf
    v_and_b32_dpp v58, v18, v10 quad_perm:[0,0,0,0] row_mask:0xf bank_mask:0xf
    v_and_b32_dpp v59, v19, v10 quad_perm:[0,0,0,0] row_mask:0xf bank_mask:0xf
    v_and_b32_dpp v60, v16, v11 quad_perm:[0,0,0,0] row_mask:0xf bank_mask:0xf
    v_and_b32_dpp v61, v17, v11 quad_perm:[0,0,0,0] row_mask:0xf bank_mask:0xf
    v_and_b32_dpp v62, v18, v11 quad_perm:[0,0,0,0] row_mask:0xf bank_mask:0xf
    v_and_b32_dpp v63, v19, v11 quad_perm:[0,0,0,0] row_mask:0xf bank_mask:0xf
    v_perm_b32 v89, v132, v128, s69
    v_perm_b32 v93, v132, v128, s70
    v_perm_b32 v97, v133, v129, s69
    v_perm_b32 v101, v133, v129, s70
    v_perm_b32 v105, v134, v130, s69
    v_perm_b32 v109, v134, v130, s70
    v_perm_b32 v113, v135, v131, s69
    v_perm_b32 v117, v135, v131, s70
    v_sub_f32 v24, v24, v12
    v_sub_f32 v25, v25, v12
    v_sub_f32 v26, v26, v12
    v_sub_f32 v27, v27, v12
    v_mul_f32 v24, 0x3fb8aa3b, v24
    v_mul_f32 v25, 0x3fb8aa3b, v25
    v_mul_f32 v26, 0x3fb8aa3b, v26
    v_mul_f32 v27, 0x3fb8aa3b, v27
    v_exp_f32 v24, v24
    v_exp_f32 v25, v25
    v_exp_f32 v26, v26
    v_exp_f32 v27, v27
    v_add_f32 v84, v24, v25
    v_add_f32 v85, v26, v27
    v_cvt_pk_bf16_f32 v24, v24, v25
    v_cvt_pk_bf16_f32 v25, v26, v27
    v_add_f32 v13, v13, v84
    v_add_f32 v13, v13, v85
    v_sub_f32 v28, v28, v12
    v_sub_f32 v29, v29, v12
    v_sub_f32 v30, v30, v12
    v_sub_f32 v31, v31, v12
    v_mul_f32 v28, 0x3fb8aa3b, v28
    v_mul_f32 v29, 0x3fb8aa3b, v29
    v_mul_f32 v30, 0x3fb8aa3b, v30
    v_mul_f32 v31, 0x3fb8aa3b, v31
    v_exp_f32 v28, v28
    v_exp_f32 v29, v29
    v_exp_f32 v30, v30
    v_exp_f32 v31, v31
    v_add_f32 v84, v28, v29
    v_add_f32 v85, v30, v31
    v_cvt_pk_bf16_f32 v26, v28, v29
    v_cvt_pk_bf16_f32 v27, v30, v31
    v_add_f32 v13, v13, v84
    v_add_f32 v13, v13, v85
    s_cbranch_vccnz L_F139
    s_waitcnt vmcnt(4)
L_F139:
    s_waitcnt vmcnt(6)
    buffer_load_dwordx4 v[164:167], v2, s[8:11], s65 offen nt
    s_addk_i32 s65, 0x1000
    s_and_b32 s65, s65, s66
    v_sub_f32 v32, v32, v12
    v_sub_f32 v33, v33, v12
    v_sub_f32 v34, v34, v12
    v_sub_f32 v35, v35, v12
    v_mul_f32 v32, 0x3fb8aa3b, v32
    v_mul_f32 v33, 0x3fb8aa3b, v33
    v_mul_f32 v34, 0x3fb8aa3b, v34
    v_mul_f32 v35, 0x3fb8aa3b, v35
    v_exp_f32 v32, v32
    v_exp_f32 v33, v33
    v_exp_f32 v34, v34
    v_exp_f32 v35, v35
    v_add_f32 v84, v32, v33
    v_add_f32 v85, v34, v35
    v_cvt_pk_bf16_f32 v32, v32, v33
    v_cvt_pk_bf16_f32 v33, v34, v35
    v_add_f32 v13, v13, v84
    v_add_f32 v13, v13, v85
    v_sub_f32 v36, v36, v12
    v_sub_f32 v37, v37, v12
    v_sub_f32 v38, v38, v12
    v_sub_f32 v39, v39, v12
    v_mul_f32 v36, 0x3fb8aa3b, v36
    v_mul_f32 v37, 0x3fb8aa3b, v37
    v_mul_f32 v38, 0x3fb8aa3b, v38
    v_mul_f32 v39, 0x3fb8aa3b, v39
    v_exp_f32 v36, v36
    v_exp_f32 v37, v37
    v_exp_f32 v38, v38
    v_exp_f32 v39, v39
    v_add_f32 v84, v36, v37
    v_add_f32 v85, v38, v39
    v_cvt_pk_bf16_f32 v34, v36, v37
    v_cvt_pk_bf16_f32 v35, v38, v39
    v_add_f32 v13, v13, v84
    v_add_f32 v13, v13, v85
    v_mov_b32 v249, 140
    ds_write_b32 v248, v249
    ds_read_b32 v250, v248 offset:1024
    s_cbranch_vccnz L_F140
    s_waitcnt vmcnt(4)
L_F140:
    s_waitcnt vmcnt(6)
    buffer_load_dwordx4 v[168:171], v2, s[8:11], s65 offen nt
    s_addk_i32 s65, 0x1000
    s_and_b32 s65, s65, s66
    v_perm_b32 v90, v140, v136, s69
    v_perm_b32 v94, v140, v136, s70
    v_perm_b32 v98, v141, v137, s69
    v_perm_b32 v102, v141, v137, s70
    v_perm_b32 v106, v142, v138, s69
    v_perm_b32 v110, v142, v138, s70
    v_perm_b32 v114, v143, v139, s69
    v_perm_b32 v118, v143, v139, s70
    v_sub_f32 v40, v40, v12
    v_sub_f32 v41, v41, v12
    v_sub_f32 v42, v42, v12
    v_sub_f32 v43, v43, v12
    v_mul_f32 v40, 0x3fb8aa3b, v40
    v_mul_f32 v41, 0x3fb8aa3b, v41
    v_mul_f32 v42, 0x3fb8aa3b, v42
    v_mul_f32 v43, 0x3fb8aa3b, v43
    v_exp_f32 v40, v40
    v_exp_f32 v41, v41
    v_exp_f32 v42, v42
    v_exp_f32 v43, v43
    v_add_f32 v84, v40, v41
    v_add_f32 v85, v42, v43
    v_cvt_pk_bf16_f32 v40, v40, v41
    v_cvt_pk_bf16_f32 v41, v42, v43
    v_add_f32 v13, v13, v84
    v_add_f32 v13, v13, v85
    v_sub_f32 v44, v44, v12
    v_sub_f32 v45, v45, v12
    v_sub_f32 v46, v46, v12
    v_sub_f32 v47, v47, v12
    v_mul_f32 v44, 0x3fb8aa3b, v44
    v_mul_f32 v45, 0x3fb8aa3b, v45
    v_mul_f32 v46, 0x3fb8aa3b, v46
    v_mul_f32 v47, 0x3fb8aa3b, v47
    v_exp_f32 v44, v44
    v_exp_f32 v45, v45
    v_exp_f32 v46, v46
    v_exp_f32 v47, v47
    v_add_f32 v84, v44, v45
    v_add_f32 v85, v46, v47
    v_cvt_pk_bf16_f32 v42, v44, v45
    v_cvt_pk_bf16_f32 v43, v46, v47
    v_add_f32 v13, v13, v84
    v_add_f32 v13, v13, v85
    s_waitcnt lgkmcnt(0)
    v_cmp_lt_i32 vcc, v249, v250
    s_cbranch_vccnz L_F141
    s_waitcnt vmcnt(4)
L_F141:
    s_waitcnt vmcnt(6)
    buffer_load_dwordx4 v[172:175], v2, s[8:11], s65 offen nt
    s_addk_i32 s65, 0x1000
    s_and_b32 s65, s65, s66
    v_add_f32_dpp v13, v13, v13 quad_perm:[1,0,3,2] row_mask:0xf bank_mask:0xf
    s_nop 1
    v_add_f32_dpp v13, v13, v13 quad_perm:[2,3,0,1] row_mask:0xf bank_mask:0xf
    v_mov_b32 v84, v13
    s_nop 1
    v_permlane16_swap_b32 v84, v13
    v_add_f32 v13, v84, v13
    v_mov_b32 v84, v13
    s_nop 1
    v_permlane32_swap_b32 v84, v13
    v_add_f32 v13, v84, v13
    v_min_u32 v12, -2, v12
    v_min_u32 v13, -2, v13
    s_lshl_b32 s81, s3, 5
    s_add_u32 s81, s81, 150784
    v_lshl_add_u32 v84, v0, 1, s81
    s_mov_b64 exec, 0x1111
    ds_write_b64 v84, v[12:13]
    s_mov_b64 exec, -1
    s_cbranch_vccnz L_F142
    s_waitcnt vmcnt(4)
L_F142:
    s_waitcnt vmcnt(6)
    buffer_load_dwordx4 v[176:179], v2, s[8:11], s65 offen nt
    s_addk_i32 s65, 0x1000
    s_and_b32 s65, s65, s66
    v_perm_b32 v91, v148, v144, s69
    v_perm_b32 v95, v148, v144, s70
    v_perm_b32 v99, v149, v145, s69
    v_perm_b32 v103, v149, v145, s70
    v_perm_b32 v107, v150, v146, s69
    v_perm_b32 v111, v150, v146, s70
    v_perm_b32 v115, v151, v147, s69
    v_perm_b32 v119, v151, v147, s70
    v_mfma_f32_16x16x32_bf16 v[64:67], v[48:51], v[88:91], v[64:67]
    v_mfma_f32_16x16x32_bf16 v[64:67], v[52:55], v[92:95], v[64:67]
    v_mfma_f32_16x16x32_bf16 v[64:67], v[56:59], v[96:99], v[64:67]
    v_mfma_f32_16x16x32_bf16 v[64:67], v[60:63], v[100:103], v[64:67]
    v_mfma_f32_16x16x32_bf16 v[68:71], v[48:51], v[104:107], v[68:71]
    v_mfma_f32_16x16x32_bf16 v[68:71], v[52:55], v[108:111], v[68:71]
    v_mfma_f32_16x16x32_bf16 v[68:71], v[56:59], v[112:115], v[68:71]
    v_mfma_f32_16x16x32_bf16 v[68:71], v[60:63], v[116:119], v[68:71]
    v_and_b32_dpp v48, v16, v8 quad_perm:[1,1,1,1] row_mask:0xf bank_mask:0xf
    v_and_b32_dpp v49, v17, v8 quad_perm:[1,1,1,1] row_mask:0xf bank_mask:0xf
    v_and_b32_dpp v50, v18, v8 quad_perm:[1,1,1,1] row_mask:0xf bank_mask:0xf
    v_and_b32_dpp v51, v19, v8 quad_perm:[1,1,1,1] row_mask:0xf bank_mask:0xf
    v_and_b32_dpp v52, v16, v9 quad_perm:[1,1,1,1] row_mask:0xf bank_mask:0xf
    v_and_b32_dpp v53, v17, v9 quad_perm:[1,1,1,1] row_mask:0xf bank_mask:0xf
    v_and_b32_dpp v54, v18, v9 quad_perm:[1,1,1,1] row_mask:0xf bank_mask:0xf
    v_and_b32_dpp v55, v19, v9 quad_perm:[1,1,1,1] row_mask:0xf bank_mask:0xf
    v_and_b32_dpp v56, v16, v10 quad_perm:[1,1,1,1] row_mask:0xf bank_mask:0xf
    v_and_b32_dpp v57, v17, v10 quad_perm:[1,1,1,1] row_mask:0xf bank_mask:0xf
    v_and_b32_dpp v58, v18, v10 quad_perm:[1,1,1,1] row_mask:0xf bank_mask:0xf
    v_and_b32_dpp v59, v19, v10 quad_perm:[1,1,1,1] row_mask:0xf bank_mask:0xf
    v_and_b32_dpp v60, v16, v11 quad_perm:[1,1,1,1] row_mask:0xf bank_mask:0xf
    v_and_b32_dpp v61, v17, v11 quad_perm:[1,1,1,1] row_mask:0xf bank_mask:0xf
    v_and_b32_dpp v62, v18, v11 quad_perm:[1,1,1,1] row_mask:0xf bank_mask:0xf
    v_and_b32_dpp v63, v19, v11 quad_perm:[1,1,1,1] row_mask:0xf bank_mask:0xf
    s_cbranch_vccnz L_F143
    s_waitcnt vmcnt(4)
L_F143:
    s_waitcnt vmcnt(6)
    buffer_load_dwordx4 v[180:183], v2, s[8:11], s65 offen nt
    s_addk_i32 s65, 0x1000
    s_and_b32 s65, s65, s66
    v_mov_b32 v249, 144
    ds_write_b32 v248, v249
    ds_read_b32 v250, v248 offset:1024
    s_cbranch_vccnz L_F144
    s_waitcnt vmcnt(4)
L_F144:
    s_waitcnt vmcnt(6)
    buffer_load_dwordx4 v[184:187], v2, s[8:11], s65 offen nt
    s_addk_i32 s65, 0x1000
    s_and_b32 s65, s65, s66
    v_perm_b32 v88, v156, v152, s69
    v_perm_b32 v92, v156, v152, s70
    v_perm_b32 v96, v157, v153, s69
    v_perm_b32 v100, v157, v153, s70
    v_perm_b32 v104, v158, v154, s69
    v_perm_b32 v108, v158, v154, s70
    v_perm_b32 v112, v159, v155, s69
    v_perm_b32 v116, v159, v155, s70
    s_waitcnt lgkmcnt(0)
    v_cmp_lt_i32 vcc, v249, v250
    s_cbranch_vccnz L_F145
    s_waitcnt vmcnt(4)
L_F145:
    s_waitcnt vmcnt(6)
    buffer_load_dwordx4 v[188:191], v2, s[8:11], s65 offen nt
    s_addk_i32 s65, 0x1000
    s_and_b32 s65, s65, s66
    s_cbranch_vccnz L_F146
    s_waitcnt vmcnt(4)
L_F146:
    s_waitcnt vmcnt(6)
    buffer_load_dwordx4 v[192:195], v2, s[8:11], s65 offen nt
    s_addk_i32 s65, 0x1000
    s_and_b32 s65, s65, s66
    v_perm_b32 v89, v164, v160, s69
    v_perm_b32 v93, v164, v160, s70
    v_perm_b32 v97, v165, v161, s69
    v_perm_b32 v101, v165, v161, s70
    v_perm_b32 v105, v166, v162, s69
    v_perm_b32 v109, v166, v162, s70
    v_perm_b32 v113, v167, v163, s69
    v_perm_b32 v117, v167, v163, s70
    s_cbranch_vccnz L_F147
    s_waitcnt vmcnt(4)
L_F147:
    s_waitcnt vmcnt(6)
    buffer_load_dwordx4 v[196:199], v2, s[8:11], s65 offen nt
    s_addk_i32 s65, 0x1000
    s_and_b32 s65, s65, s66
    v_mov_b32 v249, 148
    ds_write_b32 v248, v249
    ds_read_b32 v250, v248 offset:1024
    s_cbranch_vccnz L_F148
    s_waitcnt vmcnt(4)
L_F148:
    s_waitcnt vmcnt(6)
    buffer_load_dwordx4 v[200:203], v2, s[8:11], s65 offen nt
    s_addk_i32 s65, 0x1000
    s_and_b32 s65, s65, s66
    v_perm_b32 v90, v172, v168, s69
    v_perm_b32 v94, v172, v168, s70
    v_perm_b32 v98, v173, v169, s69
    v_perm_b32 v102, v173, v169, s70
    v_perm_b32 v106, v174, v170, s69
    v_perm_b32 v110, v174, v170, s70
    v_perm_b32 v114, v175, v171, s69
    v_perm_b32 v118, v175, v171, s70
    s_waitcnt lgkmcnt(0)
    v_cmp_lt_i32 vcc, v249, v250
    s_cbranch_vccnz L_F149
    s_waitcnt vmcnt(4)
L_F149:
    s_waitcnt vmcnt(6)
    buffer_load_dwordx4 v[204:207], v2, s[8:11], s65 offen nt
    s_addk_i32 s65, 0x1000
    s_and_b32 s65, s65, s66
    s_cbranch_vccnz L_F150
    s_waitcnt vmcnt(4)
L_F150:
    s_waitcnt vmcnt(6)
    buffer_load_dwordx4 v[208:211], v2, s[8:11], s65 offen nt
    s_addk_i32 s65, 0x1000
    s_and_b32 s65, s65, s66
    v_perm_b32 v91, v180, v176, s69
    v_perm_b32 v95, v180, v176, s70
    v_perm_b32 v99, v181, v177, s69
    v_perm_b32 v103, v181, v177, s70
    v_perm_b32 v107, v182, v178, s69
    v_perm_b32 v111, v182, v178, s70
    v_perm_b32 v115, v183, v179, s69
    v_perm_b32 v119, v183, v179, s70
    v_mfma_f32_16x16x32_bf16 v[64:67], v[48:51], v[88:91], v[64:67]
    v_mfma_f32_16x16x32_bf16 v[64:67], v[52:55], v[92:95], v[64:67]
    v_mfma_f32_16x16x32_bf16 v[64:67], v[56:59], v[96:99], v[64:67]
    v_mfma_f32_16x16x32_bf16 v[64:67], v[60:63], v[100:103], v[64:67]
    v_mfma_f32_16x16x32_bf16 v[68:71], v[48:51], v[104:107], v[68:71]
    v_mfma_f32_16x16x32_bf16 v[68:71], v[52:55], v[108:111], v[68:71]
    v_mfma_f32_16x16x32_bf16 v[68:71], v[56:59], v[112:115], v[68:71]
    v_mfma_f32_16x16x32_bf16 v[68:71], v[60:63], v[116:119], v[68:71]
    v_and_b32_dpp v48, v16, v8 quad_perm:[2,2,2,2] row_mask:0xf bank_mask:0xf
    v_and_b32_dpp v49, v17, v8 quad_perm:[2,2,2,2] row_mask:0xf bank_mask:0xf
    v_and_b32_dpp v50, v18, v8 quad_perm:[2,2,2,2] row_mask:0xf bank_mask:0xf
    v_and_b32_dpp v51, v19, v8 quad_perm:[2,2,2,2] row_mask:0xf bank_mask:0xf
    v_and_b32_dpp v52, v16, v9 quad_perm:[2,2,2,2] row_mask:0xf bank_mask:0xf
    v_and_b32_dpp v53, v17, v9 quad_perm:[2,2,2,2] row_mask:0xf bank_mask:0xf
    v_and_b32_dpp v54, v18, v9 quad_perm:[2,2,2,2] row_mask:0xf bank_mask:0xf
    v_and_b32_dpp v55, v19, v9 quad_perm:[2,2,2,2] row_mask:0xf bank_mask:0xf
    v_and_b32_dpp v56, v16, v10 quad_perm:[2,2,2,2] row_mask:0xf bank_mask:0xf
    v_and_b32_dpp v57, v17, v10 quad_perm:[2,2,2,2] row_mask:0xf bank_mask:0xf
    v_and_b32_dpp v58, v18, v10 quad_perm:[2,2,2,2] row_mask:0xf bank_mask:0xf
    v_and_b32_dpp v59, v19, v10 quad_perm:[2,2,2,2] row_mask:0xf bank_mask:0xf
    v_and_b32_dpp v60, v16, v11 quad_perm:[2,2,2,2] row_mask:0xf bank_mask:0xf
    v_and_b32_dpp v61, v17, v11 quad_perm:[2,2,2,2] row_mask:0xf bank_mask:0xf
    v_and_b32_dpp v62, v18, v11 quad_perm:[2,2,2,2] row_mask:0xf bank_mask:0xf
    v_and_b32_dpp v63, v19, v11 quad_perm:[2,2,2,2] row_mask:0xf bank_mask:0xf
    s_cbranch_vccnz L_F151
    s_waitcnt vmcnt(4)
L_F151:
    s_waitcnt vmcnt(6)
    buffer_load_dwordx4 v[212:215], v2, s[8:11], s65 offen nt
    s_addk_i32 s65, 0x1000
    s_and_b32 s65, s65, s66
    v_mov_b32 v249, 152
    ds_write_b32 v248, v249
    ds_read_b32 v250, v248 offset:1024
    s_cbranch_vccnz L_F152
    s_waitcnt vmcnt(4)
L_F152:
    s_waitcnt vmcnt(6)
    buffer_load_dwordx4 v[216:219], v2, s[8:11], s65 offen nt
    s_addk_i32 s65, 0x1000
    s_and_b32 s65, s65, s66
    v_perm_b32 v88, v188, v184, s69
    v_perm_b32 v92, v188, v184, s70
    v_perm_b32 v96, v189, v185, s69
    v_perm_b32 v100, v189, v185, s70
    v_perm_b32 v104, v190, v186, s69
    v_perm_b32 v108, v190, v186, s70
    v_perm_b32 v112, v191, v187, s69
    v_perm_b32 v116, v191, v187, s70
    s_waitcnt lgkmcnt(0)
    v_cmp_lt_i32 vcc, v249, v250
    s_cbranch_vccnz L_F153
    s_waitcnt vmcnt(4)
L_F153:
    s_waitcnt vmcnt(6)
    buffer_load_dwordx4 v[220:223], v2, s[8:11], s65 offen nt
    s_addk_i32 s65, 0x1000
    s_and_b32 s65, s65, s66
    s_cbranch_vccnz L_F154
    s_waitcnt vmcnt(4)
L_F154:
    s_waitcnt vmcnt(6)
    buffer_load_dwordx4 v[224:227], v2, s[8:11], s65 offen nt
    s_addk_i32 s65, 0x1000
    s_and_b32 s65, s65, s66
    v_perm_b32 v89, v196, v192, s69
    v_perm_b32 v93, v196, v192, s70
    v_perm_b32 v97, v197, v193, s69
    v_perm_b32 v101, v197, v193, s70
    v_perm_b32 v105, v198, v194, s69
    v_perm_b32 v109, v198, v194, s70
    v_perm_b32 v113, v199, v195, s69
    v_perm_b32 v117, v199, v195, s70
    s_cbranch_vccnz L_F155
    s_waitcnt vmcnt(4)
L_F155:
    s_waitcnt vmcnt(6)
    buffer_load_dwordx4 v[228:231], v2, s[8:11], s65 offen nt
    s_addk_i32 s65, 0x1000
    s_and_b32 s65, s65, s66
    v_mov_b32 v249, 156
    ds_write_b32 v248, v249
    ds_read_b32 v250, v248 offset:1024
    s_cbranch_vccnz L_F156
    s_waitcnt vmcnt(4)
L_F156:
    s_waitcnt vmcnt(6)
    buffer_load_dwordx4 v[232:235], v2, s[8:11], s65 offen nt
    s_addk_i32 s65, 0x1000
    s_and_b32 s65, s65, s66
    v_perm_b32 v90, v204, v200, s69
    v_perm_b32 v94, v204, v200, s70
    v_perm_b32 v98, v205, v201, s69
    v_perm_b32 v102, v205, v201, s70
    v_perm_b32 v106, v206, v202, s69
    v_perm_b32 v110, v206, v202, s70
    v_perm_b32 v114, v207, v203, s69
    v_perm_b32 v118, v207, v203, s70
    s_waitcnt lgkmcnt(0)
    v_cmp_lt_i32 vcc, v249, v250
    s_cbranch_vccnz L_F157
    s_waitcnt vmcnt(4)
L_F157:
    s_waitcnt vmcnt(6)
    buffer_load_dwordx4 v[236:239], v2, s[8:11], s65 offen nt
    s_addk_i32 s65, 0x1000
    s_and_b32 s65, s65, s66
    s_cbranch_vccnz L_F158
    s_waitcnt vmcnt(4)
L_F158:
    s_waitcnt vmcnt(6)
    buffer_load_dwordx4 v[240:243], v2, s[8:11], s65 offen nt
    s_addk_i32 s65, 0x1000
    s_and_b32 s65, s65, s66
    v_perm_b32 v91, v212, v208, s69
    v_perm_b32 v95, v212, v208, s70
    v_perm_b32 v99, v213, v209, s69
    v_perm_b32 v103, v213, v209, s70
    v_perm_b32 v107, v214, v210, s69
    v_perm_b32 v111, v214, v210, s70
    v_perm_b32 v115, v215, v211, s69
    v_perm_b32 v119, v215, v211, s70
    v_mfma_f32_16x16x32_bf16 v[64:67], v[48:51], v[88:91], v[64:67]
    v_mfma_f32_16x16x32_bf16 v[64:67], v[52:55], v[92:95], v[64:67]
    v_mfma_f32_16x16x32_bf16 v[64:67], v[56:59], v[96:99], v[64:67]
    v_mfma_f32_16x16x32_bf16 v[64:67], v[60:63], v[100:103], v[64:67]
    v_mfma_f32_16x16x32_bf16 v[68:71], v[48:51], v[104:107], v[68:71]
    v_mfma_f32_16x16x32_bf16 v[68:71], v[52:55], v[108:111], v[68:71]
    v_mfma_f32_16x16x32_bf16 v[68:71], v[56:59], v[112:115], v[68:71]
    v_mfma_f32_16x16x32_bf16 v[68:71], v[60:63], v[116:119], v[68:71]
    v_and_b32_dpp v48, v16, v8 quad_perm:[3,3,3,3] row_mask:0xf bank_mask:0xf
    v_and_b32_dpp v49, v17, v8 quad_perm:[3,3,3,3] row_mask:0xf bank_mask:0xf
    v_and_b32_dpp v50, v18, v8 quad_perm:[3,3,3,3] row_mask:0xf bank_mask:0xf
    v_and_b32_dpp v51, v19, v8 quad_perm:[3,3,3,3] row_mask:0xf bank_mask:0xf
    v_and_b32_dpp v52, v16, v9 quad_perm:[3,3,3,3] row_mask:0xf bank_mask:0xf
    v_and_b32_dpp v53, v17, v9 quad_perm:[3,3,3,3] row_mask:0xf bank_mask:0xf
    v_and_b32_dpp v54, v18, v9 quad_perm:[3,3,3,3] row_mask:0xf bank_mask:0xf
    v_and_b32_dpp v55, v19, v9 quad_perm:[3,3,3,3] row_mask:0xf bank_mask:0xf
    v_and_b32_dpp v56, v16, v10 quad_perm:[3,3,3,3] row_mask:0xf bank_mask:0xf
    v_and_b32_dpp v57, v17, v10 quad_perm:[3,3,3,3] row_mask:0xf bank_mask:0xf
    v_and_b32_dpp v58, v18, v10 quad_perm:[3,3,3,3] row_mask:0xf bank_mask:0xf
    v_and_b32_dpp v59, v19, v10 quad_perm:[3,3,3,3] row_mask:0xf bank_mask:0xf
    v_and_b32_dpp v60, v16, v11 quad_perm:[3,3,3,3] row_mask:0xf bank_mask:0xf
    v_and_b32_dpp v61, v17, v11 quad_perm:[3,3,3,3] row_mask:0xf bank_mask:0xf
    v_and_b32_dpp v62, v18, v11 quad_perm:[3,3,3,3] row_mask:0xf bank_mask:0xf
    v_and_b32_dpp v63, v19, v11 quad_perm:[3,3,3,3] row_mask:0xf bank_mask:0xf
    s_cbranch_vccnz L_F159
    s_waitcnt vmcnt(4)
L_F159:
    s_waitcnt vmcnt(6)
    buffer_load_dwordx4 v[244:247], v2, s[8:11], s65 offen nt
    s_addk_i32 s65, 0x1000
    s_and_b32 s65, s65, s66
    v_mov_b32 v249, 160
    ds_write_b32 v248, v249
    ds_read_b32 v250, v248 offset:1024
    s_cbranch_vccnz L_F160
    s_waitcnt vmcnt(4)
L_F160:
    s_waitcnt vmcnt(6)
    buffer_load_dwordx4 v[120:123], v2, s[8:11], s65 offen nt
    s_addk_i32 s65, 0x1000
    s_and_b32 s65, s65, s66
    v_perm_b32 v88, v220, v216, s69
    v_perm_b32 v92, v220, v216, s70
    v_perm_b32 v96, v221, v217, s69
    v_perm_b32 v100, v221, v217, s70
    v_perm_b32 v104, v222, v218, s69
    v_perm_b32 v108, v222, v218, s70
    v_perm_b32 v112, v223, v219, s69
    v_perm_b32 v116, v223, v219, s70
    s_waitcnt lgkmcnt(0)
    v_cmp_lt_i32 vcc, v249, v250
    s_cbranch_vccnz L_F161
    s_waitcnt vmcnt(4)
L_F161:
    s_waitcnt vmcnt(6)
    buffer_load_dwordx4 v[124:127], v2, s[8:11], s65 offen nt
    s_addk_i32 s65, 0x1000
    s_and_b32 s65, s65, s66
    s_cbranch_vccnz L_F162
    s_waitcnt vmcnt(4)
L_F162:
    s_waitcnt vmcnt(6)
    buffer_load_dwordx4 v[128:131], v2, s[8:11], s65 offen nt
    s_addk_i32 s65, 0x1000
    s_and_b32 s65, s65, s66
    v_perm_b32 v89, v228, v224, s69
    v_perm_b32 v93, v228, v224, s70
    v_perm_b32 v97, v229, v225, s69
    v_perm_b32 v101, v229, v225, s70
    v_perm_b32 v105, v230, v226, s69
    v_perm_b32 v109, v230, v226, s70
    v_perm_b32 v113, v231, v227, s69
    v_perm_b32 v117, v231, v227, s70
    s_cbranch_vccnz L_F163
    s_waitcnt vmcnt(4)
L_F163:
    s_waitcnt vmcnt(6)
    buffer_load_dwordx4 v[132:135], v2, s[8:11], s65 offen nt
    s_addk_i32 s65, 0x1000
    s_and_b32 s65, s65, s66
    v_mov_b32 v249, 164
    ds_write_b32 v248, v249
    ds_read_b32 v250, v248 offset:1024
    s_cbranch_vccnz L_F164
    s_waitcnt vmcnt(4)
L_F164:
    s_waitcnt vmcnt(6)
    buffer_load_dwordx4 v[136:139], v2, s[8:11], s65 offen nt
    s_addk_i32 s65, 0x1000
    s_and_b32 s65, s65, s66
    v_perm_b32 v90, v236, v232, s69
    v_perm_b32 v94, v236, v232, s70
    v_perm_b32 v98, v237, v233, s69
    v_perm_b32 v102, v237, v233, s70
    v_perm_b32 v106, v238, v234, s69
    v_perm_b32 v110, v238, v234, s70
    v_perm_b32 v114, v239, v235, s69
    v_perm_b32 v118, v239, v235, s70
    s_waitcnt lgkmcnt(0)
    v_cmp_lt_i32 vcc, v249, v250
    s_cbranch_vccnz L_F165
    s_waitcnt vmcnt(4)
L_F165:
    s_waitcnt vmcnt(6)
    buffer_load_dwordx4 v[140:143], v2, s[8:11], s65 offen nt
    s_addk_i32 s65, 0x1000
    s_and_b32 s65, s65, s66
    s_cbranch_vccnz L_F166
    s_waitcnt vmcnt(4)
L_F166:
    s_waitcnt vmcnt(6)
    buffer_load_dwordx4 v[144:147], v2, s[8:11], s65 offen nt
    s_addk_i32 s65, 0x1000
    s_and_b32 s65, s65, s66
    v_perm_b32 v91, v244, v240, s69
    v_perm_b32 v95, v244, v240, s70
    v_perm_b32 v99, v245, v241, s69
    v_perm_b32 v103, v245, v241, s70
    v_perm_b32 v107, v246, v242, s69
    v_perm_b32 v111, v246, v242, s70
    v_perm_b32 v115, v247, v243, s69
    v_perm_b32 v119, v247, v243, s70
    v_mfma_f32_16x16x32_bf16 v[64:67], v[48:51], v[88:91], v[64:67]
    v_mfma_f32_16x16x32_bf16 v[64:67], v[52:55], v[92:95], v[64:67]
    v_mfma_f32_16x16x32_bf16 v[64:67], v[56:59], v[96:99], v[64:67]
    v_mfma_f32_16x16x32_bf16 v[64:67], v[60:63], v[100:103], v[64:67]
    v_mfma_f32_16x16x32_bf16 v[68:71], v[48:51], v[104:107], v[68:71]
    v_mfma_f32_16x16x32_bf16 v[68:71], v[52:55], v[108:111], v[68:71]
    v_mfma_f32_16x16x32_bf16 v[68:71], v[56:59], v[112:115], v[68:71]
    v_mfma_f32_16x16x32_bf16 v[68:71], v[60:63], v[116:119], v[68:71]
    v_and_b32_dpp v48, v24, v8 quad_perm:[0,0,0,0] row_mask:0xf bank_mask:0xf
    v_and_b32_dpp v49, v25, v8 quad_perm:[0,0,0,0] row_mask:0xf bank_mask:0xf
    v_and_b32_dpp v50, v26, v8 quad_perm:[0,0,0,0] row_mask:0xf bank_mask:0xf
    v_and_b32_dpp v51, v27, v8 quad_perm:[0,0,0,0] row_mask:0xf bank_mask:0xf
    v_and_b32_dpp v52, v24, v9 quad_perm:[0,0,0,0] row_mask:0xf bank_mask:0xf
    v_and_b32_dpp v53, v25, v9 quad_perm:[0,0,0,0] row_mask:0xf bank_mask:0xf
    v_and_b32_dpp v54, v26, v9 quad_perm:[0,0,0,0] row_mask:0xf bank_mask:0xf
    v_and_b32_dpp v55, v27, v9 quad_perm:[0,0,0,0] row_mask:0xf bank_mask:0xf
    v_and_b32_dpp v56, v24, v10 quad_perm:[0,0,0,0] row_mask:0xf bank_mask:0xf
    v_and_b32_dpp v57, v25, v10 quad_perm:[0,0,0,0] row_mask:0xf bank_mask:0xf
    v_and_b32_dpp v58, v26, v10 quad_perm:[0,0,0,0] row_mask:0xf bank_mask:0xf
    v_and_b32_dpp v59, v27, v10 quad_perm:[0,0,0,0] row_mask:0xf bank_mask:0xf
    v_and_b32_dpp v60, v24, v11 quad_perm:[0,0,0,0] row_mask:0xf bank_mask:0xf
    v_and_b32_dpp v61, v25, v11 quad_perm:[0,0,0,0] row_mask:0xf bank_mask:0xf
    v_and_b32_dpp v62, v26, v11 quad_perm:[0,0,0,0] row_mask:0xf bank_mask:0xf
    v_and_b32_dpp v63, v27, v11 quad_perm:[0,0,0,0] row_mask:0xf bank_mask:0xf
    s_cbranch_vccnz L_F167
    s_waitcnt vmcnt(4)
L_F167:
    s_waitcnt vmcnt(6)
    buffer_load_dwordx4 v[148:151], v2, s[8:11], s65 offen nt
    s_addk_i32 s65, 0x1000
    s_and_b32 s65, s65, s66
    v_mov_b32 v249, 168
    ds_write_b32 v248, v249
    ds_read_b32 v250, v248 offset:1024
    s_cbranch_vccnz L_F168
    s_waitcnt vmcnt(4)
L_F168:
    s_waitcnt vmcnt(6)
    buffer_load_dwordx4 v[152:155], v2, s[8:11], s65 offen nt
    s_addk_i32 s65, 0x1000
    s_and_b32 s65, s65, s66
    v_perm_b32 v88, v124, v120, s69
    v_perm_b32 v92, v124, v120, s70
    v_perm_b32 v96, v125, v121, s69
    v_perm_b32 v100, v125, v121, s70
    v_perm_b32 v104, v126, v122, s69
    v_perm_b32 v108, v126, v122, s70
    v_perm_b32 v112, v127, v123, s69
    v_perm_b32 v116, v127, v123, s70
    s_waitcnt lgkmcnt(0)
    v_cmp_lt_i32 vcc, v249, v250
    s_cbranch_vccnz L_F169
    s_waitcnt vmcnt(4)
L_F169:
    s_waitcnt vmcnt(6)
    buffer_load_dwordx4 v[156:159], v2, s[8:11], s65 offen nt
    s_addk_i32 s65, 0x1000
    s_and_b32 s65, s65, s66
    s_cbranch_vccnz L_F170
    s_waitcnt vmcnt(4)
L_F170:
    s_waitcnt vmcnt(6)
    buffer_load_dwordx4 v[160:163], v2, s[8:11], s65 offen nt
    s_addk_i32 s65, 0x1000
    s_and_b32 s65, s65, s66
    v_perm_b32 v89, v132, v128, s69
    v_perm_b32 v93, v132, v128, s70
    v_perm_b32 v97, v133, v129, s69
    v_perm_b32 v101, v133, v129, s70
    v_perm_b32 v105, v134, v130, s69
    v_perm_b32 v109, v134, v130, s70
    v_perm_b32 v113, v135, v131, s69
    v_perm_b32 v117, v135, v131, s70
    s_cbranch_vccnz L_F171
    s_waitcnt vmcnt(4)
L_F171:
    s_waitcnt vmcnt(6)
    buffer_load_dwordx4 v[164:167], v2, s[8:11], s65 offen nt
    s_addk_i32 s65, 0x1000
    s_and_b32 s65, s65, s66
    v_mov_b32 v249, 172
    ds_write_b32 v248, v249
    ds_read_b32 v250, v248 offset:1024
    s_cbranch_vccnz L_F172
    s_waitcnt vmcnt(4)
L_F172:
    s_waitcnt vmcnt(6)
    buffer_load_dwordx4 v[168:171], v2, s[8:11], s65 offen nt
    s_addk_i32 s65, 0x1000
    s_and_b32 s65, s65, s66
    v_perm_b32 v90, v140, v136, s69
    v_perm_b32 v94, v140, v136, s70
    v_perm_b32 v98, v141, v137, s69
    v_perm_b32 v102, v141, v137, s70
    v_perm_b32 v106, v142, v138, s69
    v_perm_b32 v110, v142, v138, s70
    v_perm_b32 v114, v143, v139, s69
    v_perm_b32 v118, v143, v139, s70
    s_waitcnt lgkmcnt(0)
    v_cmp_lt_i32 vcc, v249, v250
    s_cbranch_vccnz L_F173
    s_waitcnt vmcnt(4)
L_F173:
    s_waitcnt vmcnt(6)
    buffer_load_dwordx4 v[172:175], v2, s[8:11], s65 offen nt
    s_addk_i32 s65, 0x1000
    s_and_b32 s65, s65, s66
    s_cbranch_vccnz L_F174
    s_waitcnt vmcnt(4)
L_F174:
    s_waitcnt vmcnt(6)
    buffer_load_dwordx4 v[176:179], v2, s[8:11], s65 offen nt
    s_addk_i32 s65, 0x1000
    s_and_b32 s65, s65, s66
    v_perm_b32 v91, v148, v144, s69
    v_perm_b32 v95, v148, v144, s70
    v_perm_b32 v99, v149, v145, s69
    v_perm_b32 v103, v149, v145, s70
    v_perm_b32 v107, v150, v146, s69
    v_perm_b32 v111, v150, v146, s70
    v_perm_b32 v115, v151, v147, s69
    v_perm_b32 v119, v151, v147, s70
    v_mfma_f32_16x16x32_bf16 v[64:67], v[48:51], v[88:91], v[64:67]
    v_mfma_f32_16x16x32_bf16 v[64:67], v[52:55], v[92:95], v[64:67]
    v_mfma_f32_16x16x32_bf16 v[64:67], v[56:59], v[96:99], v[64:67]
    v_mfma_f32_16x16x32_bf16 v[64:67], v[60:63], v[100:103], v[64:67]
    v_mfma_f32_16x16x32_bf16 v[68:71], v[48:51], v[104:107], v[68:71]
    v_mfma_f32_16x16x32_bf16 v[68:71], v[52:55], v[108:111], v[68:71]
    v_mfma_f32_16x16x32_bf16 v[68:71], v[56:59], v[112:115], v[68:71]
    v_mfma_f32_16x16x32_bf16 v[68:71], v[60:63], v[116:119], v[68:71]
    v_and_b32_dpp v48, v24, v8 quad_perm:[1,1,1,1] row_mask:0xf bank_mask:0xf
    v_and_b32_dpp v49, v25, v8 quad_perm:[1,1,1,1] row_mask:0xf bank_mask:0xf
    v_and_b32_dpp v50, v26, v8 quad_perm:[1,1,1,1] row_mask:0xf bank_mask:0xf
    v_and_b32_dpp v51, v27, v8 quad_perm:[1,1,1,1] row_mask:0xf bank_mask:0xf
    v_and_b32_dpp v52, v24, v9 quad_perm:[1,1,1,1] row_mask:0xf bank_mask:0xf
    v_and_b32_dpp v53, v25, v9 quad_perm:[1,1,1,1] row_mask:0xf bank_mask:0xf
    v_and_b32_dpp v54, v26, v9 quad_perm:[1,1,1,1] row_mask:0xf bank_mask:0xf
    v_and_b32_dpp v55, v27, v9 quad_perm:[1,1,1,1] row_mask:0xf bank_mask:0xf
    v_and_b32_dpp v56, v24, v10 quad_perm:[1,1,1,1] row_mask:0xf bank_mask:0xf
    v_and_b32_dpp v57, v25, v10 quad_perm:[1,1,1,1] row_mask:0xf bank_mask:0xf
    v_and_b32_dpp v58, v26, v10 quad_perm:[1,1,1,1] row_mask:0xf bank_mask:0xf
    v_and_b32_dpp v59, v27, v10 quad_perm:[1,1,1,1] row_mask:0xf bank_mask:0xf
    v_and_b32_dpp v60, v24, v11 quad_perm:[1,1,1,1] row_mask:0xf bank_mask:0xf
    v_and_b32_dpp v61, v25, v11 quad_perm:[1,1,1,1] row_mask:0xf bank_mask:0xf
    v_and_b32_dpp v62, v26, v11 quad_perm:[1,1,1,1] row_mask:0xf bank_mask:0xf
    v_and_b32_dpp v63, v27, v11 quad_perm:[1,1,1,1] row_mask:0xf bank_mask:0xf
    s_cbranch_vccnz L_F175
    s_waitcnt vmcnt(4)
L_F175:
    s_waitcnt vmcnt(6)
    buffer_load_dwordx4 v[180:183], v2, s[8:11], s65 offen nt
    s_addk_i32 s65, 0x1000
    s_and_b32 s65, s65, s66
    v_mov_b32 v249, 176
    ds_write_b32 v248, v249
    ds_read_b32 v250, v248 offset:1024
    s_cbranch_vccnz L_F176
    s_waitcnt vmcnt(4)
L_F176:
    s_waitcnt vmcnt(6)
    buffer_load_dwordx4 v[184:187], v2, s[8:11], s65 offen nt
    s_addk_i32 s65, 0x1000
    s_and_b32 s65, s65, s66
    v_perm_b32 v88, v156, v152, s69
    v_perm_b32 v92, v156, v152, s70
    v_perm_b32 v96, v157, v153, s69
    v_perm_b32 v100, v157, v153, s70
    v_perm_b32 v104, v158, v154, s69
    v_perm_b32 v108, v158, v154, s70
    v_perm_b32 v112, v159, v155, s69
    v_perm_b32 v116, v159, v155, s70
    s_waitcnt lgkmcnt(0)
    v_cmp_lt_i32 vcc, v249, v250
    s_cbranch_vccnz L_F177
    s_waitcnt vmcnt(4)
L_F177:
    s_waitcnt vmcnt(6)
    buffer_load_dwordx4 v[188:191], v2, s[8:11], s65 offen nt
    s_addk_i32 s65, 0x1000
    s_and_b32 s65, s65, s66
    s_cbranch_vccnz L_F178
    s_waitcnt vmcnt(4)
L_F178:
    s_waitcnt vmcnt(6)
    buffer_load_dwordx4 v[192:195], v2, s[8:11], s65 offen nt
    s_addk_i32 s65, 0x1000
    s_and_b32 s65, s65, s66
    v_perm_b32 v89, v164, v160, s69
    v_perm_b32 v93, v164, v160, s70
    v_perm_b32 v97, v165, v161, s69
    v_perm_b32 v101, v165, v161, s70
    v_perm_b32 v105, v166, v162, s69
    v_perm_b32 v109, v166, v162, s70
    v_perm_b32 v113, v167, v163, s69
    v_perm_b32 v117, v167, v163, s70
    s_cbranch_vccnz L_F179
    s_waitcnt vmcnt(4)
L_F179:
    s_waitcnt vmcnt(6)
    buffer_load_dwordx4 v[196:199], v2, s[8:11], s65 offen nt
    s_addk_i32 s65, 0x1000
    s_and_b32 s65, s65, s66
    v_mov_b32 v249, 180
    ds_write_b32 v248, v249
    ds_read_b32 v250, v248 offset:1024
    s_cbranch_vccnz L_F180
    s_waitcnt vmcnt(4)
L_F180:
    s_waitcnt vmcnt(6)
    buffer_load_dwordx4 v[200:203], v2, s[8:11], s65 offen nt
    s_addk_i32 s65, 0x1000
    s_and_b32 s65, s65, s66
    v_perm_b32 v90, v172, v168, s69
    v_perm_b32 v94, v172, v168, s70
    v_perm_b32 v98, v173, v169, s69
    v_perm_b32 v102, v173, v169, s70
    v_perm_b32 v106, v174, v170, s69
    v_perm_b32 v110, v174, v170, s70
    v_perm_b32 v114, v175, v171, s69
    v_perm_b32 v118, v175, v171, s70
    s_waitcnt lgkmcnt(0)
    v_cmp_lt_i32 vcc, v249, v250
    s_cbranch_vccnz L_F181
    s_waitcnt vmcnt(4)
L_F181:
    s_waitcnt vmcnt(6)
    buffer_load_dwordx4 v[204:207], v2, s[8:11], s65 offen nt
    s_addk_i32 s65, 0x1000
    s_and_b32 s65, s65, s66
    s_cbranch_vccnz L_F182
    s_waitcnt vmcnt(4)
L_F182:
    s_waitcnt vmcnt(6)
    buffer_load_dwordx4 v[208:211], v2, s[8:11], s65 offen nt
    s_addk_i32 s65, 0x1000
    s_and_b32 s65, s65, s66
    v_perm_b32 v91, v180, v176, s69
    v_perm_b32 v95, v180, v176, s70
    v_perm_b32 v99, v181, v177, s69
    v_perm_b32 v103, v181, v177, s70
    v_perm_b32 v107, v182, v178, s69
    v_perm_b32 v111, v182, v178, s70
    v_perm_b32 v115, v183, v179, s69
    v_perm_b32 v119, v183, v179, s70
    v_mfma_f32_16x16x32_bf16 v[64:67], v[48:51], v[88:91], v[64:67]
    v_mfma_f32_16x16x32_bf16 v[64:67], v[52:55], v[92:95], v[64:67]
    v_mfma_f32_16x16x32_bf16 v[64:67], v[56:59], v[96:99], v[64:67]
    v_mfma_f32_16x16x32_bf16 v[64:67], v[60:63], v[100:103], v[64:67]
    v_mfma_f32_16x16x32_bf16 v[68:71], v[48:51], v[104:107], v[68:71]
    v_mfma_f32_16x16x32_bf16 v[68:71], v[52:55], v[108:111], v[68:71]
    v_mfma_f32_16x16x32_bf16 v[68:71], v[56:59], v[112:115], v[68:71]
    v_mfma_f32_16x16x32_bf16 v[68:71], v[60:63], v[116:119], v[68:71]
    v_and_b32_dpp v48, v24, v8 quad_perm:[2,2,2,2] row_mask:0xf bank_mask:0xf
    v_and_b32_dpp v49, v25, v8 quad_perm:[2,2,2,2] row_mask:0xf bank_mask:0xf
    v_and_b32_dpp v50, v26, v8 quad_perm:[2,2,2,2] row_mask:0xf bank_mask:0xf
    v_and_b32_dpp v51, v27, v8 quad_perm:[2,2,2,2] row_mask:0xf bank_mask:0xf
    v_and_b32_dpp v52, v24, v9 quad_perm:[2,2,2,2] row_mask:0xf bank_mask:0xf
    v_and_b32_dpp v53, v25, v9 quad_perm:[2,2,2,2] row_mask:0xf bank_mask:0xf
    v_and_b32_dpp v54, v26, v9 quad_perm:[2,2,2,2] row_mask:0xf bank_mask:0xf
    v_and_b32_dpp v55, v27, v9 quad_perm:[2,2,2,2] row_mask:0xf bank_mask:0xf
    v_and_b32_dpp v56, v24, v10 quad_perm:[2,2,2,2] row_mask:0xf bank_mask:0xf
    v_and_b32_dpp v57, v25, v10 quad_perm:[2,2,2,2] row_mask:0xf bank_mask:0xf
    v_and_b32_dpp v58, v26, v10 quad_perm:[2,2,2,2] row_mask:0xf bank_mask:0xf
    v_and_b32_dpp v59, v27, v10 quad_perm:[2,2,2,2] row_mask:0xf bank_mask:0xf
    v_and_b32_dpp v60, v24, v11 quad_perm:[2,2,2,2] row_mask:0xf bank_mask:0xf
    v_and_b32_dpp v61, v25, v11 quad_perm:[2,2,2,2] row_mask:0xf bank_mask:0xf
    v_and_b32_dpp v62, v26, v11 quad_perm:[2,2,2,2] row_mask:0xf bank_mask:0xf
    v_and_b32_dpp v63, v27, v11 quad_perm:[2,2,2,2] row_mask:0xf bank_mask:0xf
    s_cbranch_vccnz L_F183
    s_waitcnt vmcnt(4)
L_F183:
    s_waitcnt vmcnt(6)
    buffer_load_dwordx4 v[212:215], v2, s[8:11], s65 offen nt
    s_addk_i32 s65, 0x1000
    s_and_b32 s65, s65, s66
    v_mov_b32 v249, 184
    ds_write_b32 v248, v249
    ds_read_b32 v250, v248 offset:1024
    s_cbranch_vccnz L_F184
    s_waitcnt vmcnt(4)
L_F184:
    s_waitcnt vmcnt(6)
    buffer_load_dwordx4 v[216:219], v2, s[8:11], s65 offen nt
    s_addk_i32 s65, 0x1000
    s_and_b32 s65, s65, s66
    v_perm_b32 v88, v188, v184, s69
    v_perm_b32 v92, v188, v184, s70
    v_perm_b32 v96, v189, v185, s69
    v_perm_b32 v100, v189, v185, s70
    v_perm_b32 v104, v190, v186, s69
    v_perm_b32 v108, v190, v186, s70
    v_perm_b32 v112, v191, v187, s69
    v_perm_b32 v116, v191, v187, s70
    s_waitcnt lgkmcnt(0)
    v_cmp_lt_i32 vcc, v249, v250
    s_cbranch_vccnz L_F185
    s_waitcnt vmcnt(4)
L_F185:
    s_waitcnt vmcnt(6)
    buffer_load_dwordx4 v[220:223], v2, s[8:11], s65 offen nt
    s_addk_i32 s65, 0x1000
    s_and_b32 s65, s65, s66
    s_cbranch_vccnz L_F186
    s_waitcnt vmcnt(4)
L_F186:
    s_waitcnt vmcnt(6)
    buffer_load_dwordx4 v[224:227], v2, s[8:11], s65 offen nt
    s_addk_i32 s65, 0x1000
    s_and_b32 s65, s65, s66
    v_perm_b32 v89, v196, v192, s69
    v_perm_b32 v93, v196, v192, s70
    v_perm_b32 v97, v197, v193, s69
    v_perm_b32 v101, v197, v193, s70
    v_perm_b32 v105, v198, v194, s69
    v_perm_b32 v109, v198, v194, s70
    v_perm_b32 v113, v199, v195, s69
    v_perm_b32 v117, v199, v195, s70
    s_cbranch_vccnz L_F187
    s_waitcnt vmcnt(4)
L_F187:
    s_waitcnt vmcnt(6)
    buffer_load_dwordx4 v[228:231], v2, s[8:11], s65 offen nt
    s_addk_i32 s65, 0x1000
    s_and_b32 s65, s65, s66
    v_mov_b32 v249, 188
    ds_write_b32 v248, v249
    ds_read_b32 v250, v248 offset:1024
    s_cbranch_vccnz L_F188
    s_waitcnt vmcnt(4)
L_F188:
    s_waitcnt vmcnt(6)
    buffer_load_dwordx4 v[232:235], v2, s[8:11], s65 offen nt
    s_addk_i32 s65, 0x1000
    s_and_b32 s65, s65, s66
    v_perm_b32 v90, v204, v200, s69
    v_perm_b32 v94, v204, v200, s70
    v_perm_b32 v98, v205, v201, s69
    v_perm_b32 v102, v205, v201, s70
    v_perm_b32 v106, v206, v202, s69
    v_perm_b32 v110, v206, v202, s70
    v_perm_b32 v114, v207, v203, s69
    v_perm_b32 v118, v207, v203, s70
    s_waitcnt lgkmcnt(0)
    v_cmp_lt_i32 vcc, v249, v250
    s_cbranch_vccnz L_F189
    s_waitcnt vmcnt(4)
L_F189:
    s_waitcnt vmcnt(6)
    buffer_load_dwordx4 v[236:239], v2, s[8:11], s65 offen nt
    s_addk_i32 s65, 0x1000
    s_and_b32 s65, s65, s66
    s_cbranch_vccnz L_F190
    s_waitcnt vmcnt(4)
L_F190:
    s_waitcnt vmcnt(6)
    buffer_load_dwordx4 v[240:243], v2, s[8:11], s65 offen nt
    s_addk_i32 s65, 0x1000
    s_and_b32 s65, s65, s66
    v_perm_b32 v91, v212, v208, s69
    v_perm_b32 v95, v212, v208, s70
    v_perm_b32 v99, v213, v209, s69
    v_perm_b32 v103, v213, v209, s70
    v_perm_b32 v107, v214, v210, s69
    v_perm_b32 v111, v214, v210, s70
    v_perm_b32 v115, v215, v211, s69
    v_perm_b32 v119, v215, v211, s70
    v_mfma_f32_16x16x32_bf16 v[64:67], v[48:51], v[88:91], v[64:67]
    v_mfma_f32_16x16x32_bf16 v[64:67], v[52:55], v[92:95], v[64:67]
    v_mfma_f32_16x16x32_bf16 v[64:67], v[56:59], v[96:99], v[64:67]
    v_mfma_f32_16x16x32_bf16 v[64:67], v[60:63], v[100:103], v[64:67]
    v_mfma_f32_16x16x32_bf16 v[68:71], v[48:51], v[104:107], v[68:71]
    v_mfma_f32_16x16x32_bf16 v[68:71], v[52:55], v[108:111], v[68:71]
    v_mfma_f32_16x16x32_bf16 v[68:71], v[56:59], v[112:115], v[68:71]
    v_mfma_f32_16x16x32_bf16 v[68:71], v[60:63], v[116:119], v[68:71]
    v_and_b32_dpp v48, v24, v8 quad_perm:[3,3,3,3] row_mask:0xf bank_mask:0xf
    v_and_b32_dpp v49, v25, v8 quad_perm:[3,3,3,3] row_mask:0xf bank_mask:0xf
    v_and_b32_dpp v50, v26, v8 quad_perm:[3,3,3,3] row_mask:0xf bank_mask:0xf
    v_and_b32_dpp v51, v27, v8 quad_perm:[3,3,3,3] row_mask:0xf bank_mask:0xf
    v_and_b32_dpp v52, v24, v9 quad_perm:[3,3,3,3] row_mask:0xf bank_mask:0xf
    v_and_b32_dpp v53, v25, v9 quad_perm:[3,3,3,3] row_mask:0xf bank_mask:0xf
    v_and_b32_dpp v54, v26, v9 quad_perm:[3,3,3,3] row_mask:0xf bank_mask:0xf
    v_and_b32_dpp v55, v27, v9 quad_perm:[3,3,3,3] row_mask:0xf bank_mask:0xf
    v_and_b32_dpp v56, v24, v10 quad_perm:[3,3,3,3] row_mask:0xf bank_mask:0xf
    v_and_b32_dpp v57, v25, v10 quad_perm:[3,3,3,3] row_mask:0xf bank_mask:0xf
    v_and_b32_dpp v58, v26, v10 quad_perm:[3,3,3,3] row_mask:0xf bank_mask:0xf
    v_and_b32_dpp v59, v27, v10 quad_perm:[3,3,3,3] row_mask:0xf bank_mask:0xf
    v_and_b32_dpp v60, v24, v11 quad_perm:[3,3,3,3] row_mask:0xf bank_mask:0xf
    v_and_b32_dpp v61, v25, v11 quad_perm:[3,3,3,3] row_mask:0xf bank_mask:0xf
    v_and_b32_dpp v62, v26, v11 quad_perm:[3,3,3,3] row_mask:0xf bank_mask:0xf
    v_and_b32_dpp v63, v27, v11 quad_perm:[3,3,3,3] row_mask:0xf bank_mask:0xf
    s_cbranch_vccnz L_F191
    s_waitcnt vmcnt(4)
L_F191:
    s_waitcnt vmcnt(6)
    buffer_load_dwordx4 v[244:247], v2, s[8:11], s65 offen nt
    s_addk_i32 s65, 0x1000
    s_and_b32 s65, s65, s66
    v_mov_b32 v249, 192
    ds_write_b32 v248, v249
    ds_read_b32 v250, v248 offset:1024
    s_cbranch_vccnz L_F192
    s_waitcnt vmcnt(4)
L_F192:
    s_waitcnt vmcnt(6)
    buffer_load_dwordx4 v[120:123], v2, s[8:11], s65 offen nt
    s_addk_i32 s65, 0x1000
    s_and_b32 s65, s65, s66
    v_perm_b32 v88, v220, v216, s69
    v_perm_b32 v92, v220, v216, s70
    v_perm_b32 v96, v221, v217, s69
    v_perm_b32 v100, v221, v217, s70
    v_perm_b32 v104, v222, v218, s69
    v_perm_b32 v108, v222, v218, s70
    v_perm_b32 v112, v223, v219, s69
    v_perm_b32 v116, v223, v219, s70
    s_waitcnt lgkmcnt(0)
    v_cmp_lt_i32 vcc, v249, v250
    s_cbranch_vccnz L_F193
    s_waitcnt vmcnt(4)
L_F193:
    s_waitcnt vmcnt(6)
    buffer_load_dwordx4 v[124:127], v2, s[8:11], s65 offen nt
    s_addk_i32 s65, 0x1000
    s_and_b32 s65, s65, s66
    s_cbranch_vccnz L_F194
    s_waitcnt vmcnt(4)
L_F194:
    s_waitcnt vmcnt(6)
    buffer_load_dwordx4 v[128:131], v2, s[8:11], s65 offen nt
    s_addk_i32 s65, 0x1000
    s_and_b32 s65, s65, s66
    v_perm_b32 v89, v228, v224, s69
    v_perm_b32 v93, v228, v224, s70
    v_perm_b32 v97, v229, v225, s69
    v_perm_b32 v101, v229, v225, s70
    v_perm_b32 v105, v230, v226, s69
    v_perm_b32 v109, v230, v226, s70
    v_perm_b32 v113, v231, v227, s69
    v_perm_b32 v117, v231, v227, s70
    s_cbranch_vccnz L_F195
    s_waitcnt vmcnt(4)
L_F195:
    s_waitcnt vmcnt(6)
    buffer_load_dwordx4 v[132:135], v2, s[8:11], s65 offen nt
    s_addk_i32 s65, 0x1000
    s_and_b32 s65, s65, s66
    v_mov_b32 v249, 196
    ds_write_b32 v248, v249
    ds_read_b32 v250, v248 offset:1024
    s_cbranch_vccnz L_F196
    s_waitcnt vmcnt(4)
L_F196:
    s_waitcnt vmcnt(6)
    buffer_load_dwordx4 v[136:139], v2, s[8:11], s65 offen nt
    s_addk_i32 s65, 0x1000
    s_and_b32 s65, s65, s66
    v_perm_b32 v90, v236, v232, s69
    v_perm_b32 v94, v236, v232, s70
    v_perm_b32 v98, v237, v233, s69
    v_perm_b32 v102, v237, v233, s70
    v_perm_b32 v106, v238, v234, s69
    v_perm_b32 v110, v238, v234, s70
    v_perm_b32 v114, v239, v235, s69
    v_perm_b32 v118, v239, v235, s70
    s_waitcnt lgkmcnt(0)
    v_cmp_lt_i32 vcc, v249, v250
    s_cbranch_vccnz L_F197
    s_waitcnt vmcnt(4)
L_F197:
    s_waitcnt vmcnt(6)
    buffer_load_dwordx4 v[140:143], v2, s[8:11], s65 offen nt
    s_addk_i32 s65, 0x1000
    s_and_b32 s65, s65, s66
    s_cbranch_vccnz L_F198
    s_waitcnt vmcnt(4)
L_F198:
    s_waitcnt vmcnt(6)
    buffer_load_dwordx4 v[144:147], v2, s[8:11], s65 offen nt
    s_addk_i32 s65, 0x1000
    s_and_b32 s65, s65, s66
    v_perm_b32 v91, v244, v240, s69
    v_perm_b32 v95, v244, v240, s70
    v_perm_b32 v99, v245, v241, s69
    v_perm_b32 v103, v245, v241, s70
    v_perm_b32 v107, v246, v242, s69
    v_perm_b32 v111, v246, v242, s70
    v_perm_b32 v115, v247, v243, s69
    v_perm_b32 v119, v247, v243, s70
    v_mfma_f32_16x16x32_bf16 v[64:67], v[48:51], v[88:91], v[64:67]
    v_mfma_f32_16x16x32_bf16 v[64:67], v[52:55], v[92:95], v[64:67]
    v_mfma_f32_16x16x32_bf16 v[64:67], v[56:59], v[96:99], v[64:67]
    v_mfma_f32_16x16x32_bf16 v[64:67], v[60:63], v[100:103], v[64:67]
    v_mfma_f32_16x16x32_bf16 v[68:71], v[48:51], v[104:107], v[68:71]
    v_mfma_f32_16x16x32_bf16 v[68:71], v[52:55], v[108:111], v[68:71]
    v_mfma_f32_16x16x32_bf16 v[68:71], v[56:59], v[112:115], v[68:71]
    v_mfma_f32_16x16x32_bf16 v[68:71], v[60:63], v[116:119], v[68:71]
    v_and_b32_dpp v48, v32, v8 quad_perm:[0,0,0,0] row_mask:0xf bank_mask:0xf
    v_and_b32_dpp v49, v33, v8 quad_perm:[0,0,0,0] row_mask:0xf bank_mask:0xf
    v_and_b32_dpp v50, v34, v8 quad_perm:[0,0,0,0] row_mask:0xf bank_mask:0xf
    v_and_b32_dpp v51, v35, v8 quad_perm:[0,0,0,0] row_mask:0xf bank_mask:0xf
    v_and_b32_dpp v52, v32, v9 quad_perm:[0,0,0,0] row_mask:0xf bank_mask:0xf
    v_and_b32_dpp v53, v33, v9 quad_perm:[0,0,0,0] row_mask:0xf bank_mask:0xf
    v_and_b32_dpp v54, v34, v9 quad_perm:[0,0,0,0] row_mask:0xf bank_mask:0xf
    v_and_b32_dpp v55, v35, v9 quad_perm:[0,0,0,0] row_mask:0xf bank_mask:0xf
    v_and_b32_dpp v56, v32, v10 quad_perm:[0,0,0,0] row_mask:0xf bank_mask:0xf
    v_and_b32_dpp v57, v33, v10 quad_perm:[0,0,0,0] row_mask:0xf bank_mask:0xf
    v_and_b32_dpp v58, v34, v10 quad_perm:[0,0,0,0] row_mask:0xf bank_mask:0xf
    v_and_b32_dpp v59, v35, v10 quad_perm:[0,0,0,0] row_mask:0xf bank_mask:0xf
    v_and_b32_dpp v60, v32, v11 quad_perm:[0,0,0,0] row_mask:0xf bank_mask:0xf
    v_and_b32_dpp v61, v33, v11 quad_perm:[0,0,0,0] row_mask:0xf bank_mask:0xf
    v_and_b32_dpp v62, v34, v11 quad_perm:[0,0,0,0] row_mask:0xf bank_mask:0xf
    v_and_b32_dpp v63, v35, v11 quad_perm:[0,0,0,0] row_mask:0xf bank_mask:0xf
    s_cbranch_vccnz L_F199
    s_waitcnt vmcnt(4)
L_F199:
    s_waitcnt vmcnt(6)
    buffer_load_dwordx4 v[148:151], v2, s[8:11], s65 offen nt
    s_addk_i32 s65, 0x1000
    s_and_b32 s65, s65, s66
    v_mov_b32 v249, 200
    ds_write_b32 v248, v249
    ds_read_b32 v250, v248 offset:1024
    s_cbranch_vccnz L_F200
    s_waitcnt vmcnt(4)
L_F200:
    s_waitcnt vmcnt(6)
    buffer_load_dwordx4 v[152:155], v2, s[8:11], s65 offen nt
    s_addk_i32 s65, 0x1000
    s_and_b32 s65, s65, s66
    v_perm_b32 v88, v124, v120, s69
    v_perm_b32 v92, v124, v120, s70
    v_perm_b32 v96, v125, v121, s69
    v_perm_b32 v100, v125, v121, s70
    v_perm_b32 v104, v126, v122, s69
    v_perm_b32 v108, v126, v122, s70
    v_perm_b32 v112, v127, v123, s69
    v_perm_b32 v116, v127, v123, s70
    s_waitcnt lgkmcnt(0)
    v_cmp_lt_i32 vcc, v249, v250
    s_cbranch_vccnz L_F201
    s_waitcnt vmcnt(4)
L_F201:
    s_waitcnt vmcnt(6)
    buffer_load_dwordx4 v[156:159], v2, s[8:11], s65 offen nt
    s_addk_i32 s65, 0x1000
    s_and_b32 s65, s65, s66
    s_cbranch_vccnz L_F202
    s_waitcnt vmcnt(4)
L_F202:
    s_waitcnt vmcnt(6)
    buffer_load_dwordx4 v[160:163], v2, s[8:11], s65 offen nt
    s_addk_i32 s65, 0x1000
    s_and_b32 s65, s65, s66
    v_perm_b32 v89, v132, v128, s69
    v_perm_b32 v93, v132, v128, s70
    v_perm_b32 v97, v133, v129, s69
    v_perm_b32 v101, v133, v129, s70
    v_perm_b32 v105, v134, v130, s69
    v_perm_b32 v109, v134, v130, s70
    v_perm_b32 v113, v135, v131, s69
    v_perm_b32 v117, v135, v131, s70
    s_cbranch_vccnz L_F203
    s_waitcnt vmcnt(4)
L_F203:
    s_waitcnt vmcnt(6)
    buffer_load_dwordx4 v[164:167], v2, s[8:11], s65 offen nt
    s_addk_i32 s65, 0x1000
    s_and_b32 s65, s65, s66
    v_mov_b32 v249, 204
    ds_write_b32 v248, v249
    ds_read_b32 v250, v248 offset:1024
    s_cbranch_vccnz L_F204
    s_waitcnt vmcnt(4)
L_F204:
    s_waitcnt vmcnt(6)
    buffer_load_dwordx4 v[168:171], v2, s[8:11], s65 offen nt
    s_addk_i32 s65, 0x1000
    s_and_b32 s65, s65, s66
    v_perm_b32 v90, v140, v136, s69
    v_perm_b32 v94, v140, v136, s70
    v_perm_b32 v98, v141, v137, s69
    v_perm_b32 v102, v141, v137, s70
    v_perm_b32 v106, v142, v138, s69
    v_perm_b32 v110, v142, v138, s70
    v_perm_b32 v114, v143, v139, s69
    v_perm_b32 v118, v143, v139, s70
    s_waitcnt lgkmcnt(0)
    v_cmp_lt_i32 vcc, v249, v250
    s_cbranch_vccnz L_F205
    s_waitcnt vmcnt(4)
L_F205:
    s_waitcnt vmcnt(6)
    buffer_load_dwordx4 v[172:175], v2, s[8:11], s65 offen nt
    s_addk_i32 s65, 0x1000
    s_and_b32 s65, s65, s66
    s_cbranch_vccnz L_F206
    s_waitcnt vmcnt(4)
L_F206:
    s_waitcnt vmcnt(6)
    buffer_load_dwordx4 v[176:179], v2, s[8:11], s65 offen nt
    s_addk_i32 s65, 0x1000
    s_and_b32 s65, s65, s66
    v_perm_b32 v91, v148, v144, s69
    v_perm_b32 v95, v148, v144, s70
    v_perm_b32 v99, v149, v145, s69
    v_perm_b32 v103, v149, v145, s70
    v_perm_b32 v107, v150, v146, s69
    v_perm_b32 v111, v150, v146, s70
    v_perm_b32 v115, v151, v147, s69
    v_perm_b32 v119, v151, v147, s70
    v_mfma_f32_16x16x32_bf16 v[64:67], v[48:51], v[88:91], v[64:67]
    v_mfma_f32_16x16x32_bf16 v[64:67], v[52:55], v[92:95], v[64:67]
    v_mfma_f32_16x16x32_bf16 v[64:67], v[56:59], v[96:99], v[64:67]
    v_mfma_f32_16x16x32_bf16 v[64:67], v[60:63], v[100:103], v[64:67]
    v_mfma_f32_16x16x32_bf16 v[68:71], v[48:51], v[104:107], v[68:71]
    v_mfma_f32_16x16x32_bf16 v[68:71], v[52:55], v[108:111], v[68:71]
    v_mfma_f32_16x16x32_bf16 v[68:71], v[56:59], v[112:115], v[68:71]
    v_mfma_f32_16x16x32_bf16 v[68:71], v[60:63], v[116:119], v[68:71]
    v_and_b32_dpp v48, v32, v8 quad_perm:[1,1,1,1] row_mask:0xf bank_mask:0xf
    v_and_b32_dpp v49, v33, v8 quad_perm:[1,1,1,1] row_mask:0xf bank_mask:0xf
    v_and_b32_dpp v50, v34, v8 quad_perm:[1,1,1,1] row_mask:0xf bank_mask:0xf
    v_and_b32_dpp v51, v35, v8 quad_perm:[1,1,1,1] row_mask:0xf bank_mask:0xf
    v_and_b32_dpp v52, v32, v9 quad_perm:[1,1,1,1] row_mask:0xf bank_mask:0xf
    v_and_b32_dpp v53, v33, v9 quad_perm:[1,1,1,1] row_mask:0xf bank_mask:0xf
    v_and_b32_dpp v54, v34, v9 quad_perm:[1,1,1,1] row_mask:0xf bank_mask:0xf
    v_and_b32_dpp v55, v35, v9 quad_perm:[1,1,1,1] row_mask:0xf bank_mask:0xf
    v_and_b32_dpp v56, v32, v10 quad_perm:[1,1,1,1] row_mask:0xf bank_mask:0xf
    v_and_b32_dpp v57, v33, v10 quad_perm:[1,1,1,1] row_mask:0xf bank_mask:0xf
    v_and_b32_dpp v58, v34, v10 quad_perm:[1,1,1,1] row_mask:0xf bank_mask:0xf
    v_and_b32_dpp v59, v35, v10 quad_perm:[1,1,1,1] row_mask:0xf bank_mask:0xf
    v_and_b32_dpp v60, v32, v11 quad_perm:[1,1,1,1] row_mask:0xf bank_mask:0xf
    v_and_b32_dpp v61, v33, v11 quad_perm:[1,1,1,1] row_mask:0xf bank_mask:0xf
    v_and_b32_dpp v62, v34, v11 quad_perm:[1,1,1,1] row_mask:0xf bank_mask:0xf
    v_and_b32_dpp v63, v35, v11 quad_perm:[1,1,1,1] row_mask:0xf bank_mask:0xf
    s_cbranch_vccnz L_F207
    s_waitcnt vmcnt(4)
L_F207:
    s_waitcnt vmcnt(6)
    buffer_load_dwordx4 v[180:183], v2, s[8:11], s65 offen nt
    s_addk_i32 s65, 0x1000
    s_and_b32 s65, s65, s66
    v_mov_b32 v249, 208
    ds_write_b32 v248, v249
    ds_read_b32 v250, v248 offset:1024
    s_cbranch_vccnz L_F208
    s_waitcnt vmcnt(4)
L_F208:
    s_waitcnt vmcnt(6)
    buffer_load_dwordx4 v[184:187], v2, s[8:11], s65 offen nt
    s_addk_i32 s65, 0x1000
    s_and_b32 s65, s65, s66
    v_mov_b32 v14, 150912
    s_mov_b64 exec, 1
    ds_write_b32 v14, v14
    s_mov_b64 exec, -1
    v_perm_b32 v88, v156, v152, s69
    v_perm_b32 v92, v156, v152, s70
    v_perm_b32 v96, v157, v153, s69
    v_perm_b32 v100, v157, v153, s70
    v_perm_b32 v104, v158, v154, s69
    v_perm_b32 v108, v158, v154, s70
    v_perm_b32 v112, v159, v155, s69
    v_perm_b32 v116, v159, v155, s70
    s_waitcnt lgkmcnt(0)
    v_cmp_lt_i32 vcc, v249, v250
    s_cbranch_vccnz L_F209
    s_waitcnt vmcnt(4)
L_F209:
    s_waitcnt vmcnt(6)
    buffer_load_dwordx4 v[188:191], v2, s[8:11], s65 offen nt
    s_addk_i32 s65, 0x1000
    s_and_b32 s65, s65, s66
    s_cbranch_vccnz L_F210
    s_waitcnt vmcnt(4)
L_F210:
    s_waitcnt vmcnt(6)
    buffer_load_dwordx4 v[192:195], v2, s[8:11], s65 offen nt
    s_addk_i32 s65, 0x1000
    s_and_b32 s65, s65, s66
    v_perm_b32 v89, v164, v160, s69
    v_perm_b32 v93, v164, v160, s70
    v_perm_b32 v97, v165, v161, s69
    v_perm_b32 v101, v165, v161, s70
    v_perm_b32 v105, v166, v162, s69
    v_perm_b32 v109, v166, v162, s70
    v_perm_b32 v113, v167, v163, s69
    v_perm_b32 v117, v167, v163, s70
    s_cbranch_vccnz L_F211
    s_waitcnt vmcnt(4)
L_F211:
    s_waitcnt vmcnt(6)
    buffer_load_dwordx4 v[196:199], v2, s[8:11], s65 offen nt
    s_addk_i32 s65, 0x1000
    s_and_b32 s65, s65, s66
    v_mov_b32 v249, 212
    ds_write_b32 v248, v249
    ds_read_b32 v250, v248 offset:1024
    s_cbranch_vccnz L_F212
    s_waitcnt vmcnt(4)
L_F212:
    s_waitcnt vmcnt(6)
    buffer_load_dwordx4 v[200:203], v2, s[8:11], s65 offen nt
    s_addk_i32 s65, 0x1000
    s_and_b32 s65, s65, s66
    v_perm_b32 v90, v172, v168, s69
    v_perm_b32 v94, v172, v168, s70
    v_perm_b32 v98, v173, v169, s69
    v_perm_b32 v102, v173, v169, s70
    v_perm_b32 v106, v174, v170, s69
    v_perm_b32 v110, v174, v170, s70
    v_perm_b32 v114, v175, v171, s69
    v_perm_b32 v118, v175, v171, s70
    s_waitcnt lgkmcnt(0)
    v_cmp_lt_i32 vcc, v249, v250
    s_cbranch_vccnz L_F213
    s_waitcnt vmcnt(4)
L_F213:
    s_waitcnt vmcnt(6)
    buffer_load_dwordx4 v[204:207], v2, s[8:11], s65 offen nt
    s_addk_i32 s65, 0x1000
    s_and_b32 s65, s65, s66
    s_cbranch_vccnz L_F214
    s_waitcnt vmcnt(4)
L_F214:
    s_waitcnt vmcnt(6)
    buffer_load_dwordx4 v[208:211], v2, s[8:11], s65 offen nt
    s_addk_i32 s65, 0x1000
    s_and_b32 s65, s65, s66
    v_perm_b32 v91, v180, v176, s69
    v_perm_b32 v95, v180, v176, s70
    v_perm_b32 v99, v181, v177, s69
    v_perm_b32 v103, v181, v177, s70
    v_perm_b32 v107, v182, v178, s69
    v_perm_b32 v111, v182, v178, s70
    v_perm_b32 v115, v183, v179, s69
    v_perm_b32 v119, v183, v179, s70
    v_mfma_f32_16x16x32_bf16 v[64:67], v[48:51], v[88:91], v[64:67]
    v_mfma_f32_16x16x32_bf16 v[64:67], v[52:55], v[92:95], v[64:67]
    v_mfma_f32_16x16x32_bf16 v[64:67], v[56:59], v[96:99], v[64:67]
    v_mfma_f32_16x16x32_bf16 v[64:67], v[60:63], v[100:103], v[64:67]
    v_mfma_f32_16x16x32_bf16 v[68:71], v[48:51], v[104:107], v[68:71]
    v_mfma_f32_16x16x32_bf16 v[68:71], v[52:55], v[108:111], v[68:71]
    v_mfma_f32_16x16x32_bf16 v[68:71], v[56:59], v[112:115], v[68:71]
    v_mfma_f32_16x16x32_bf16 v[68:71], v[60:63], v[116:119], v[68:71]
    v_and_b32_dpp v48, v32, v8 quad_perm:[2,2,2,2] row_mask:0xf bank_mask:0xf
    v_and_b32_dpp v49, v33, v8 quad_perm:[2,2,2,2] row_mask:0xf bank_mask:0xf
    v_and_b32_dpp v50, v34, v8 quad_perm:[2,2,2,2] row_mask:0xf bank_mask:0xf
    v_and_b32_dpp v51, v35, v8 quad_perm:[2,2,2,2] row_mask:0xf bank_mask:0xf
    v_and_b32_dpp v52, v32, v9 quad_perm:[2,2,2,2] row_mask:0xf bank_mask:0xf
    v_and_b32_dpp v53, v33, v9 quad_perm:[2,2,2,2] row_mask:0xf bank_mask:0xf
    v_and_b32_dpp v54, v34, v9 quad_perm:[2,2,2,2] row_mask:0xf bank_mask:0xf
    v_and_b32_dpp v55, v35, v9 quad_perm:[2,2,2,2] row_mask:0xf bank_mask:0xf
    v_and_b32_dpp v56, v32, v10 quad_perm:[2,2,2,2] row_mask:0xf bank_mask:0xf
    v_and_b32_dpp v57, v33, v10 quad_perm:[2,2,2,2] row_mask:0xf bank_mask:0xf
    v_and_b32_dpp v58, v34, v10 quad_perm:[2,2,2,2] row_mask:0xf bank_mask:0xf
    v_and_b32_dpp v59, v35, v10 quad_perm:[2,2,2,2] row_mask:0xf bank_mask:0xf
    v_and_b32_dpp v60, v32, v11 quad_perm:[2,2,2,2] row_mask:0xf bank_mask:0xf
    v_and_b32_dpp v61, v33, v11 quad_perm:[2,2,2,2] row_mask:0xf bank_mask:0xf
    v_and_b32_dpp v62, v34, v11 quad_perm:[2,2,2,2] row_mask:0xf bank_mask:0xf
    v_and_b32_dpp v63, v35, v11 quad_perm:[2,2,2,2] row_mask:0xf bank_mask:0xf
    s_cbranch_vccnz L_F215
    s_waitcnt vmcnt(4)
L_F215:
    s_waitcnt vmcnt(6)
    buffer_load_dwordx4 v[212:215], v2, s[8:11], s65 offen nt
    s_addk_i32 s65, 0x1000
    s_and_b32 s65, s65, s66
    v_mov_b32 v249, 216
    ds_write_b32 v248, v249
    ds_read_b32 v250, v248 offset:1024
    s_cbranch_vccnz L_F216
    s_waitcnt vmcnt(4)
L_F216:
    s_waitcnt vmcnt(6)
    buffer_load_dwordx4 v[216:219], v2, s[8:11], s65 offen nt
    s_addk_i32 s65, 0x1000
    s_and_b32 s65, s65, s66
    v_perm_b32 v88, v188, v184, s69
    v_perm_b32 v92, v188, v184, s70
    v_perm_b32 v96, v189, v185, s69
    v_perm_b32 v100, v189, v185, s70
    v_perm_b32 v104, v190, v186, s69
    v_perm_b32 v108, v190, v186, s70
    v_perm_b32 v112, v191, v187, s69
    v_perm_b32 v116, v191, v187, s70
    s_waitcnt lgkmcnt(0)
    v_cmp_lt_i32 vcc, v249, v250
    s_cbranch_vccnz L_F217
    s_waitcnt vmcnt(4)
L_F217:
    s_waitcnt vmcnt(6)
    buffer_load_dwordx4 v[220:223], v2, s[8:11], s65 offen nt
    s_addk_i32 s65, 0x1000
    s_and_b32 s65, s65, s66
    s_cbranch_vccnz L_F218
    s_waitcnt vmcnt(4)
L_F218:
    s_waitcnt vmcnt(6)
    buffer_load_dwordx4 v[224:227], v2, s[8:11], s65 offen nt
    s_addk_i32 s65, 0x1000
    s_and_b32 s65, s65, s66
    v_perm_b32 v89, v196, v192, s69
    v_perm_b32 v93, v196, v192, s70
    v_perm_b32 v97, v197, v193, s69
    v_perm_b32 v101, v197, v193, s70
    v_perm_b32 v105, v198, v194, s69
    v_perm_b32 v109, v198, v194, s70
    v_perm_b32 v113, v199, v195, s69
    v_perm_b32 v117, v199, v195, s70
    s_cbranch_vccnz L_F219
    s_waitcnt vmcnt(4)
L_F219:
    s_waitcnt vmcnt(6)
    buffer_load_dwordx4 v[228:231], v2, s[8:11], s65 offen nt
    s_addk_i32 s65, 0x1000
    s_and_b32 s65, s65, s66
    v_mov_b32 v249, 220
    ds_write_b32 v248, v249
    ds_read_b32 v250, v248 offset:1024
    s_cbranch_vccnz L_F220
    s_waitcnt vmcnt(4)
L_F220:
    s_waitcnt vmcnt(6)
    buffer_load_dwordx4 v[232:235], v2, s[8:11], s65 offen nt
    s_addk_i32 s65, 0x1000
    s_and_b32 s65, s65, s66
    v_perm_b32 v90, v204, v200, s69
    v_perm_b32 v94, v204, v200, s70
    v_perm_b32 v98, v205, v201, s69
    v_perm_b32 v102, v205, v201, s70
    v_perm_b32 v106, v206, v202, s69
    v_perm_b32 v110, v206, v202, s70
    v_perm_b32 v114, v207, v203, s69
    v_perm_b32 v118, v207, v203, s70
    s_waitcnt lgkmcnt(0)
    v_cmp_lt_i32 vcc, v249, v250
    s_cbranch_vccnz L_F221
    s_waitcnt vmcnt(4)
L_F221:
    s_waitcnt vmcnt(6)
    buffer_load_dwordx4 v[236:239], v2, s[8:11], s65 offen nt
    s_addk_i32 s65, 0x1000
    s_and_b32 s65, s65, s66
    s_cbranch_vccnz L_F222
    s_waitcnt vmcnt(4)
L_F222:
    s_waitcnt vmcnt(6)
    buffer_load_dwordx4 v[240:243], v2, s[8:11], s65 offen nt
    s_addk_i32 s65, 0x1000
    s_and_b32 s65, s65, s66
    v_perm_b32 v91, v212, v208, s69
    v_perm_b32 v95, v212, v208, s70
    v_perm_b32 v99, v213, v209, s69
    v_perm_b32 v103, v213, v209, s70
    v_perm_b32 v107, v214, v210, s69
    v_perm_b32 v111, v214, v210, s70
    v_perm_b32 v115, v215, v211, s69
    v_perm_b32 v119, v215, v211, s70
    v_mfma_f32_16x16x32_bf16 v[64:67], v[48:51], v[88:91], v[64:67]
    v_mfma_f32_16x16x32_bf16 v[64:67], v[52:55], v[92:95], v[64:67]
    v_mfma_f32_16x16x32_bf16 v[64:67], v[56:59], v[96:99], v[64:67]
    v_mfma_f32_16x16x32_bf16 v[64:67], v[60:63], v[100:103], v[64:67]
    v_mfma_f32_16x16x32_bf16 v[68:71], v[48:51], v[104:107], v[68:71]
    v_mfma_f32_16x16x32_bf16 v[68:71], v[52:55], v[108:111], v[68:71]
    v_mfma_f32_16x16x32_bf16 v[68:71], v[56:59], v[112:115], v[68:71]
    v_mfma_f32_16x16x32_bf16 v[68:71], v[60:63], v[116:119], v[68:71]
    v_and_b32_dpp v48, v32, v8 quad_perm:[3,3,3,3] row_mask:0xf bank_mask:0xf
    v_and_b32_dpp v49, v33, v8 quad_perm:[3,3,3,3] row_mask:0xf bank_mask:0xf
    v_and_b32_dpp v50, v34, v8 quad_perm:[3,3,3,3] row_mask:0xf bank_mask:0xf
    v_and_b32_dpp v51, v35, v8 quad_perm:[3,3,3,3] row_mask:0xf bank_mask:0xf
    v_and_b32_dpp v52, v32, v9 quad_perm:[3,3,3,3] row_mask:0xf bank_mask:0xf
    v_and_b32_dpp v53, v33, v9 quad_perm:[3,3,3,3] row_mask:0xf bank_mask:0xf
    v_and_b32_dpp v54, v34, v9 quad_perm:[3,3,3,3] row_mask:0xf bank_mask:0xf
    v_and_b32_dpp v55, v35, v9 quad_perm:[3,3,3,3] row_mask:0xf bank_mask:0xf
    v_and_b32_dpp v56, v32, v10 quad_perm:[3,3,3,3] row_mask:0xf bank_mask:0xf
    v_and_b32_dpp v57, v33, v10 quad_perm:[3,3,3,3] row_mask:0xf bank_mask:0xf
    v_and_b32_dpp v58, v34, v10 quad_perm:[3,3,3,3] row_mask:0xf bank_mask:0xf
    v_and_b32_dpp v59, v35, v10 quad_perm:[3,3,3,3] row_mask:0xf bank_mask:0xf
    v_and_b32_dpp v60, v32, v11 quad_perm:[3,3,3,3] row_mask:0xf bank_mask:0xf
    v_and_b32_dpp v61, v33, v11 quad_perm:[3,3,3,3] row_mask:0xf bank_mask:0xf
    v_and_b32_dpp v62, v34, v11 quad_perm:[3,3,3,3] row_mask:0xf bank_mask:0xf
    v_and_b32_dpp v63, v35, v11 quad_perm:[3,3,3,3] row_mask:0xf bank_mask:0xf
    s_cbranch_vccnz L_F223
    s_waitcnt vmcnt(4)
L_F223:
    s_waitcnt vmcnt(6)
    buffer_load_dwordx4 v[244:247], v2, s[8:11], s65 offen nt
    s_addk_i32 s65, 0x1000
    s_and_b32 s65, s65, s66
    v_mov_b32 v249, 224
    ds_write_b32 v248, v249
    ds_read_b32 v250, v248 offset:1024
    s_cbranch_vccnz L_F224
    s_waitcnt vmcnt(4)
L_F224:
    s_waitcnt vmcnt(6)
    buffer_load_dwordx4 v[120:123], v2, s[8:11], s65 offen nt
    s_addk_i32 s65, 0x1000
    s_and_b32 s65, s65, s66
    v_perm_b32 v88, v220, v216, s69
    v_perm_b32 v92, v220, v216, s70
    v_perm_b32 v96, v221, v217, s69
    v_perm_b32 v100, v221, v217, s70
    v_perm_b32 v104, v222, v218, s69
    v_perm_b32 v108, v222, v218, s70
    v_perm_b32 v112, v223, v219, s69
    v_perm_b32 v116, v223, v219, s70
    s_waitcnt lgkmcnt(0)
    v_cmp_lt_i32 vcc, v249, v250
    s_cbranch_vccnz L_F225
    s_waitcnt vmcnt(4)
L_F225:
    s_waitcnt vmcnt(6)
    buffer_load_dwordx4 v[124:127], v2, s[8:11], s65 offen nt
    s_addk_i32 s65, 0x1000
    s_and_b32 s65, s65, s66
    s_cbranch_vccnz L_F226
    s_waitcnt vmcnt(4)
L_F226:
    s_waitcnt vmcnt(6)
    buffer_load_dwordx4 v[128:131], v2, s[8:11], s65 offen nt
    s_addk_i32 s65, 0x1000
    s_and_b32 s65, s65, s66
    v_perm_b32 v89, v228, v224, s69
    v_perm_b32 v93, v228, v224, s70
    v_perm_b32 v97, v229, v225, s69
    v_perm_b32 v101, v229, v225, s70
    v_perm_b32 v105, v230, v226, s69
    v_perm_b32 v109, v230, v226, s70
    v_perm_b32 v113, v231, v227, s69
    v_perm_b32 v117, v231, v227, s70
    s_cbranch_vccnz L_F227
    s_waitcnt vmcnt(4)
L_F227:
    s_waitcnt vmcnt(6)
    buffer_load_dwordx4 v[132:135], v2, s[8:11], s65 offen nt
    s_addk_i32 s65, 0x1000
    s_and_b32 s65, s65, s66
    v_mov_b32 v249, 228
    ds_write_b32 v248, v249
    ds_read_b32 v250, v248 offset:1024
    s_cbranch_vccnz L_F228
    s_waitcnt vmcnt(4)
L_F228:
    s_waitcnt vmcnt(6)
    buffer_load_dwordx4 v[136:139], v2, s[8:11], s65 offen nt
    s_addk_i32 s65, 0x1000
    s_and_b32 s65, s65, s66
    v_perm_b32 v90, v236, v232, s69
    v_perm_b32 v94, v236, v232, s70
    v_perm_b32 v98, v237, v233, s69
    v_perm_b32 v102, v237, v233, s70
    v_perm_b32 v106, v238, v234, s69
    v_perm_b32 v110, v238, v234, s70
    v_perm_b32 v114, v239, v235, s69
    v_perm_b32 v118, v239, v235, s70
    s_waitcnt lgkmcnt(0)
    v_cmp_lt_i32 vcc, v249, v250
    s_cbranch_vccnz L_F229
    s_waitcnt vmcnt(4)
L_F229:
    s_waitcnt vmcnt(6)
    buffer_load_dwordx4 v[140:143], v2, s[8:11], s65 offen nt
    s_addk_i32 s65, 0x1000
    s_and_b32 s65, s65, s66
    s_cbranch_vccnz L_F230
    s_waitcnt vmcnt(4)
L_F230:
    s_waitcnt vmcnt(6)
    buffer_load_dwordx4 v[144:147], v2, s[8:11], s65 offen nt
    s_addk_i32 s65, 0x1000
    s_and_b32 s65, s65, s66
    v_perm_b32 v91, v244, v240, s69
    v_perm_b32 v95, v244, v240, s70
    v_perm_b32 v99, v245, v241, s69
    v_perm_b32 v103, v245, v241, s70
    v_perm_b32 v107, v246, v242, s69
    v_perm_b32 v111, v246, v242, s70
    v_perm_b32 v115, v247, v243, s69
    v_perm_b32 v119, v247, v243, s70
    v_mfma_f32_16x16x32_bf16 v[64:67], v[48:51], v[88:91], v[64:67]
    v_mfma_f32_16x16x32_bf16 v[64:67], v[52:55], v[92:95], v[64:67]
    v_mfma_f32_16x16x32_bf16 v[64:67], v[56:59], v[96:99], v[64:67]
    v_mfma_f32_16x16x32_bf16 v[64:67], v[60:63], v[100:103], v[64:67]
    v_mfma_f32_16x16x32_bf16 v[68:71], v[48:51], v[104:107], v[68:71]
    v_mfma_f32_16x16x32_bf16 v[68:71], v[52:55], v[108:111], v[68:71]
    v_mfma_f32_16x16x32_bf16 v[68:71], v[56:59], v[112:115], v[68:71]
    v_mfma_f32_16x16x32_bf16 v[68:71], v[60:63], v[116:119], v[68:71]
    v_and_b32_dpp v48, v40, v8 quad_perm:[0,0,0,0] row_mask:0xf bank_mask:0xf
    v_and_b32_dpp v49, v41, v8 quad_perm:[0,0,0,0] row_mask:0xf bank_mask:0xf
    v_and_b32_dpp v50, v42, v8 quad_perm:[0,0,0,0] row_mask:0xf bank_mask:0xf
    v_and_b32_dpp v51, v43, v8 quad_perm:[0,0,0,0] row_mask:0xf bank_mask:0xf
    v_and_b32_dpp v52, v40, v9 quad_perm:[0,0,0,0] row_mask:0xf bank_mask:0xf
    v_and_b32_dpp v53, v41, v9 quad_perm:[0,0,0,0] row_mask:0xf bank_mask:0xf
    v_and_b32_dpp v54, v42, v9 quad_perm:[0,0,0,0] row_mask:0xf bank_mask:0xf
    v_and_b32_dpp v55, v43, v9 quad_perm:[0,0,0,0] row_mask:0xf bank_mask:0xf
    v_and_b32_dpp v56, v40, v10 quad_perm:[0,0,0,0] row_mask:0xf bank_mask:0xf
    v_and_b32_dpp v57, v41, v10 quad_perm:[0,0,0,0] row_mask:0xf bank_mask:0xf
    v_and_b32_dpp v58, v42, v10 quad_perm:[0,0,0,0] row_mask:0xf bank_mask:0xf
    v_and_b32_dpp v59, v43, v10 quad_perm:[0,0,0,0] row_mask:0xf bank_mask:0xf
    v_and_b32_dpp v60, v40, v11 quad_perm:[0,0,0,0] row_mask:0xf bank_mask:0xf
    v_and_b32_dpp v61, v41, v11 quad_perm:[0,0,0,0] row_mask:0xf bank_mask:0xf
    v_and_b32_dpp v62, v42, v11 quad_perm:[0,0,0,0] row_mask:0xf bank_mask:0xf
    v_and_b32_dpp v63, v43, v11 quad_perm:[0,0,0,0] row_mask:0xf bank_mask:0xf
    s_cbranch_vccnz L_F231
    s_waitcnt vmcnt(4)
L_F231:
    s_waitcnt vmcnt(6)
    buffer_load_dwordx4 v[148:151], v2, s[8:11], s65 offen nt
    s_addk_i32 s65, 0x1000
    s_and_b32 s65, s65, s66
    v_mov_b32 v249, 232
    ds_write_b32 v248, v249
    ds_read_b32 v250, v248 offset:1024
    s_cbranch_vccnz L_F232
    s_waitcnt vmcnt(4)
L_F232:
    s_waitcnt vmcnt(6)
    buffer_load_dwordx4 v[152:155], v2, s[8:11], s65 offen nt
    s_addk_i32 s65, 0x1000
    s_and_b32 s65, s65, s66
    v_perm_b32 v88, v124, v120, s69
    v_perm_b32 v92, v124, v120, s70
    v_perm_b32 v96, v125, v121, s69
    v_perm_b32 v100, v125, v121, s70
    v_perm_b32 v104, v126, v122, s69
    v_perm_b32 v108, v126, v122, s70
    v_perm_b32 v112, v127, v123, s69
    v_perm_b32 v116, v127, v123, s70
    s_waitcnt lgkmcnt(0)
    v_cmp_lt_i32 vcc, v249, v250
    s_cbranch_vccnz L_F233
    s_waitcnt vmcnt(4)
L_F233:
    s_waitcnt vmcnt(6)
    buffer_load_dwordx4 v[156:159], v2, s[8:11], s65 offen nt
    s_addk_i32 s65, 0x1000
    s_and_b32 s65, s65, s66
    s_cbranch_vccnz L_F234
    s_waitcnt vmcnt(4)
L_F234:
    s_waitcnt vmcnt(6)
    buffer_load_dwordx4 v[160:163], v2, s[8:11], s65 offen nt
    s_addk_i32 s65, 0x1000
    s_and_b32 s65, s65, s66
    v_perm_b32 v89, v132, v128, s69
    v_perm_b32 v93, v132, v128, s70
    v_perm_b32 v97, v133, v129, s69
    v_perm_b32 v101, v133, v129, s70
    v_perm_b32 v105, v134, v130, s69
    v_perm_b32 v109, v134, v130, s70
    v_perm_b32 v113, v135, v131, s69
    v_perm_b32 v117, v135, v131, s70
    s_cbranch_vccnz L_F235
    s_waitcnt vmcnt(4)
L_F235:
    s_waitcnt vmcnt(6)
    buffer_load_dwordx4 v[164:167], v2, s[8:11], s65 offen nt
    s_addk_i32 s65, 0x1000
    s_and_b32 s65, s65, s66
    v_mov_b32 v249, 236
    ds_write_b32 v248, v249
    ds_read_b32 v250, v248 offset:1024
    s_cbranch_vccnz L_F236
    s_waitcnt vmcnt(4)
L_F236:
    s_waitcnt vmcnt(6)
    buffer_load_dwordx4 v[168:171], v2, s[8:11], s65 offen nt
    s_addk_i32 s65, 0x1000
    s_and_b32 s65, s65, s66
    v_perm_b32 v90, v140, v136, s69
    v_perm_b32 v94, v140, v136, s70
    v_perm_b32 v98, v141, v137, s69
    v_perm_b32 v102, v141, v137, s70
    v_perm_b32 v106, v142, v138, s69
    v_perm_b32 v110, v142, v138, s70
    v_perm_b32 v114, v143, v139, s69
    v_perm_b32 v118, v143, v139, s70
    s_waitcnt lgkmcnt(0)
    v_cmp_lt_i32 vcc, v249, v250
    s_cbranch_vccnz L_F237
    s_waitcnt vmcnt(4)
L_F237:
    s_waitcnt vmcnt(6)
    buffer_load_dwordx4 v[172:175], v2, s[8:11], s65 offen nt
    s_addk_i32 s65, 0x1000
    s_and_b32 s65, s65, s66
    s_cbranch_vccnz L_F238
    s_waitcnt vmcnt(4)
L_F238:
    s_waitcnt vmcnt(6)
    buffer_load_dwordx4 v[176:179], v2, s[8:11], s65 offen nt
    s_addk_i32 s65, 0x1000
    s_and_b32 s65, s65, s66
    v_perm_b32 v91, v148, v144, s69
    v_perm_b32 v95, v148, v144, s70
    v_perm_b32 v99, v149, v145, s69
    v_perm_b32 v103, v149, v145, s70
    v_perm_b32 v107, v150, v146, s69
    v_perm_b32 v111, v150, v146, s70
    v_perm_b32 v115, v151, v147, s69
    v_perm_b32 v119, v151, v147, s70
    v_mfma_f32_16x16x32_bf16 v[64:67], v[48:51], v[88:91], v[64:67]
    v_mfma_f32_16x16x32_bf16 v[64:67], v[52:55], v[92:95], v[64:67]
    v_mfma_f32_16x16x32_bf16 v[64:67], v[56:59], v[96:99], v[64:67]
    v_mfma_f32_16x16x32_bf16 v[64:67], v[60:63], v[100:103], v[64:67]
    v_mfma_f32_16x16x32_bf16 v[68:71], v[48:51], v[104:107], v[68:71]
    v_mfma_f32_16x16x32_bf16 v[68:71], v[52:55], v[108:111], v[68:71]
    v_mfma_f32_16x16x32_bf16 v[68:71], v[56:59], v[112:115], v[68:71]
    v_mfma_f32_16x16x32_bf16 v[68:71], v[60:63], v[116:119], v[68:71]
    v_and_b32_dpp v48, v40, v8 quad_perm:[1,1,1,1] row_mask:0xf bank_mask:0xf
    v_and_b32_dpp v49, v41, v8 quad_perm:[1,1,1,1] row_mask:0xf bank_mask:0xf
    v_and_b32_dpp v50, v42, v8 quad_perm:[1,1,1,1] row_mask:0xf bank_mask:0xf
    v_and_b32_dpp v51, v43, v8 quad_perm:[1,1,1,1] row_mask:0xf bank_mask:0xf
    v_and_b32_dpp v52, v40, v9 quad_perm:[1,1,1,1] row_mask:0xf bank_mask:0xf
    v_and_b32_dpp v53, v41, v9 quad_perm:[1,1,1,1] row_mask:0xf bank_mask:0xf
    v_and_b32_dpp v54, v42, v9 quad_perm:[1,1,1,1] row_mask:0xf bank_mask:0xf
    v_and_b32_dpp v55, v43, v9 quad_perm:[1,1,1,1] row_mask:0xf bank_mask:0xf
    v_and_b32_dpp v56, v40, v10 quad_perm:[1,1,1,1] row_mask:0xf bank_mask:0xf
    v_and_b32_dpp v57, v41, v10 quad_perm:[1,1,1,1] row_mask:0xf bank_mask:0xf
    v_and_b32_dpp v58, v42, v10 quad_perm:[1,1,1,1] row_mask:0xf bank_mask:0xf
    v_and_b32_dpp v59, v43, v10 quad_perm:[1,1,1,1] row_mask:0xf bank_mask:0xf
    v_and_b32_dpp v60, v40, v11 quad_perm:[1,1,1,1] row_mask:0xf bank_mask:0xf
    v_and_b32_dpp v61, v41, v11 quad_perm:[1,1,1,1] row_mask:0xf bank_mask:0xf
    v_and_b32_dpp v62, v42, v11 quad_perm:[1,1,1,1] row_mask:0xf bank_mask:0xf
    v_and_b32_dpp v63, v43, v11 quad_perm:[1,1,1,1] row_mask:0xf bank_mask:0xf
    s_cbranch_vccnz L_F239
    s_waitcnt vmcnt(4)
L_F239:
    s_waitcnt vmcnt(6)
    buffer_load_dwordx4 v[180:183], v2, s[8:11], s65 offen nt
    s_addk_i32 s65, 0x1000
    s_and_b32 s65, s65, s66
    v_mov_b32 v249, 240
    ds_write_b32 v248, v249
    ds_read_b32 v250, v248 offset:1024
    s_cbranch_vccnz L_F240
    s_waitcnt vmcnt(4)
L_F240:
    s_waitcnt vmcnt(6)
    buffer_load_dwordx4 v[184:187], v2, s[8:11], s65 offen nt
    s_addk_i32 s65, 0x1000
    s_and_b32 s65, s65, s66
    v_perm_b32 v88, v156, v152, s69
    v_perm_b32 v92, v156, v152, s70
    v_perm_b32 v96, v157, v153, s69
    v_perm_b32 v100, v157, v153, s70
    v_perm_b32 v104, v158, v154, s69
    v_perm_b32 v108, v158, v154, s70
    v_perm_b32 v112, v159, v155, s69
    v_perm_b32 v116, v159, v155, s70
    s_waitcnt lgkmcnt(0)
    v_cmp_lt_i32 vcc, v249, v250
    s_cbranch_vccnz L_F241
    s_waitcnt vmcnt(4)
L_F241:
    s_waitcnt vmcnt(6)
    buffer_load_dwordx4 v[188:191], v2, s[8:11], s65 offen nt
    s_addk_i32 s65, 0x1000
    s_and_b32 s65, s65, s66
    s_cbranch_vccnz L_F242
    s_waitcnt vmcnt(4)
L_F242:
    s_waitcnt vmcnt(6)
    buffer_load_dwordx4 v[192:195], v2, s[8:11], s65 offen nt
    s_addk_i32 s65, 0x1000
    s_and_b32 s65, s65, s66
    v_perm_b32 v89, v164, v160, s69
    v_perm_b32 v93, v164, v160, s70
    v_perm_b32 v97, v165, v161, s69
    v_perm_b32 v101, v165, v161, s70
    v_perm_b32 v105, v166, v162, s69
    v_perm_b32 v109, v166, v162, s70
    v_perm_b32 v113, v167, v163, s69
    v_perm_b32 v117, v167, v163, s70
    s_cbranch_vccnz L_F243
    s_waitcnt vmcnt(4)
L_F243:
    s_waitcnt vmcnt(6)
    buffer_load_dwordx4 v[196:199], v2, s[8:11], s65 offen nt
    s_addk_i32 s65, 0x1000
    s_and_b32 s65, s65, s66
    v_mov_b32 v249, 244
    ds_write_b32 v248, v249
    ds_read_b32 v250, v248 offset:1024
    s_cbranch_vccnz L_F244
    s_waitcnt vmcnt(4)
L_F244:
    s_waitcnt vmcnt(6)
    buffer_load_dwordx4 v[200:203], v2, s[8:11], s65 offen nt
    s_addk_i32 s65, 0x1000
    s_and_b32 s65, s65, s66
    s_add_u32 s28, s28, 0x9b35e3c1
    v_and_b32 v83, 1, v0
    v_lshlrev_b32 v83, 4, v83
    v_lshrrev_b32 v83, v83, s28
    v_bfe_u32 v80, v83, 0, 4
    v_bfe_u32 v81, v83, 4, 4
    v_bfe_u32 v82, v83, 8, 4
    v_bfe_u32 v83, v83, 12, 4
    s_add_u32 s33, s62, 0
    s_and_b32 s33, s33, 7
    s_mov_b32 s34, s63
    s_lshl_b32 s81, s33, 19
    s_lshr_b32 s82, s34, 2
    s_lshl_b32 s82, s82, 16
    s_add_u32 s81, s81, s82
    s_lshl_b32 s82, s3, 14
    s_add_u32 s81, s81, s82
    s_and_b32 s82, s34, 3
    s_lshl_b32 s82, s82, 8
    s_add_u32 s81, s81, s82
    v_and_b32 v14, 15, v0
    v_lshlrev_b32 v14, 4, v14
    v_lshl_add_u32 v14, v7, 10, v14
    v_add_u32 v1, s81, v14
    s_lshl_b32 s81, s33, 18
    s_lshr_b32 s83, s34, 3
    s_lshl_b32 s83, s83, 16
    s_add_u32 s81, s81, s83
    s_add_u32 s81, s81, s82
    s_and_b32 s83, s34, 4
    s_lshl_b32 s83, s83, 10
    s_add_u32 s81, s81, s83
    s_lshl_b32 s83, s3, 14
    s_add_u32 s81, s81, s83
    v_add_u32 v251, s81, v14
    s_mov_b32 s4, s52
    s_mov_b32 s5, s53
    s_mov_b32 s6, 1835008
    s_mov_b32 s7, 0x20000
    s_lshl_b32 s81, s3, 4
    s_add_u32 s81, s81, 151552
    v_lshl_add_u32 v252, v7, 2, s81
    v_lshlrev_b32 v6, 4, v0
    v_add_u32 v3, s68, v6
    v_and_b32 v14, 1, v0
    v_lshlrev_b32 v14, 10, v14
    v_lshrrev_b32 v15, 1, v0
    v_lshl_add_u32 v4, v15, 4, v14
    s_lshl_b32 s81, s3, 8
    v_add_u32 v4, s81, v4
    s_lshl_b32 s81, s62, 16
    s_lshl_b32 s82, s3, 14
    s_add_u32 s82, s82, s81
    s_lshl_b32 s83, s63, 8
    s_add_u32 s82, s82, s83
    v_and_b32 v14, 15, v0
    v_lshlrev_b32 v14, 4, v14
    v_lshl_add_u32 v5, v7, 13, v14
    v_add_u32 v5, s82, v5
    s_lshl_b32 s81, s33, 16
    s_lshr_b32 s82, s34, 2
    s_lshl_b32 s82, s82, 13
    s_add_u32 s82, s82, s81
    s_lshl_b32 s81, s3, 6
    s_add_u32 s82, s82, s81
    v_lshrrev_b32 v14, 2, v0
    v_lshlrev_b32 v14, 8, v14
    v_and_b32 v15, 3, v0
    v_lshl_add_u32 v6, v15, 4, v14
    v_add_u32 v6, s82, v6
    s_movk_i32 s29, 0x1000
    s_waitcnt lgkmcnt(0)
    v_cmp_lt_i32 vcc, v249, v250
    s_cbranch_vccnz L_F245
    s_waitcnt vmcnt(4)
L_F245:
    s_waitcnt vmcnt(6)
    buffer_load_dwordx4 v[204:207], v2, s[8:11], s65 offen nt
    s_addk_i32 s65, 0x1000
    s_and_b32 s65, s65, s66
    v_perm_b32 v90, v172, v168, s69
    v_perm_b32 v94, v172, v168, s70
    v_perm_b32 v98, v173, v169, s69
    v_perm_b32 v102, v173, v169, s70
    v_perm_b32 v106, v174, v170, s69
    v_perm_b32 v110, v174, v170, s70
    v_perm_b32 v114, v175, v171, s69
    v_perm_b32 v118, v175, v171, s70
    s_cbranch_vccnz L_F246
    s_waitcnt vmcnt(4)
L_F246:
    s_waitcnt vmcnt(6)
    buffer_load_dwordx4 v[208:211], v2, s[8:11], s65 offen nt
    s_addk_i32 s65, 0x1000
    s_and_b32 s65, s65, s66
    v_perm_b32 v91, v180, v176, s69
    v_perm_b32 v95, v180, v176, s70
    v_perm_b32 v99, v181, v177, s69
    v_perm_b32 v103, v181, v177, s70
    v_perm_b32 v107, v182, v178, s69
    v_perm_b32 v111, v182, v178, s70
    v_perm_b32 v115, v183, v179, s69
    v_perm_b32 v119, v183, v179, s70
    v_mfma_f32_16x16x32_bf16 v[64:67], v[48:51], v[88:91], v[64:67]
    v_mfma_f32_16x16x32_bf16 v[64:67], v[52:55], v[92:95], v[64:67]
    v_mfma_f32_16x16x32_bf16 v[64:67], v[56:59], v[96:99], v[64:67]
    v_mfma_f32_16x16x32_bf16 v[64:67], v[60:63], v[100:103], v[64:67]
    v_mfma_f32_16x16x32_bf16 v[68:71], v[48:51], v[104:107], v[68:71]
    v_mfma_f32_16x16x32_bf16 v[68:71], v[52:55], v[108:111], v[68:71]
    v_mfma_f32_16x16x32_bf16 v[68:71], v[56:59], v[112:115], v[68:71]
    v_mfma_f32_16x16x32_bf16 v[68:71], v[60:63], v[116:119], v[68:71]
    v_and_b32_dpp v48, v40, v8 quad_perm:[2,2,2,2] row_mask:0xf bank_mask:0xf
    v_and_b32_dpp v49, v41, v8 quad_perm:[2,2,2,2] row_mask:0xf bank_mask:0xf
    v_and_b32_dpp v50, v42, v8 quad_perm:[2,2,2,2] row_mask:0xf bank_mask:0xf
    v_and_b32_dpp v51, v43, v8 quad_perm:[2,2,2,2] row_mask:0xf bank_mask:0xf
    v_and_b32_dpp v52, v40, v9 quad_perm:[2,2,2,2] row_mask:0xf bank_mask:0xf
    v_and_b32_dpp v53, v41, v9 quad_perm:[2,2,2,2] row_mask:0xf bank_mask:0xf
    v_and_b32_dpp v54, v42, v9 quad_perm:[2,2,2,2] row_mask:0xf bank_mask:0xf
    v_and_b32_dpp v55, v43, v9 quad_perm:[2,2,2,2] row_mask:0xf bank_mask:0xf
    v_and_b32_dpp v56, v40, v10 quad_perm:[2,2,2,2] row_mask:0xf bank_mask:0xf
    v_and_b32_dpp v57, v41, v10 quad_perm:[2,2,2,2] row_mask:0xf bank_mask:0xf
    v_and_b32_dpp v58, v42, v10 quad_perm:[2,2,2,2] row_mask:0xf bank_mask:0xf
    v_and_b32_dpp v59, v43, v10 quad_perm:[2,2,2,2] row_mask:0xf bank_mask:0xf
    v_and_b32_dpp v60, v40, v11 quad_perm:[2,2,2,2] row_mask:0xf bank_mask:0xf
    v_and_b32_dpp v61, v41, v11 quad_perm:[2,2,2,2] row_mask:0xf bank_mask:0xf
    v_and_b32_dpp v62, v42, v11 quad_perm:[2,2,2,2] row_mask:0xf bank_mask:0xf
    v_and_b32_dpp v63, v43, v11 quad_perm:[2,2,2,2] row_mask:0xf bank_mask:0xf
    s_cbranch_vccnz L_F247
    s_waitcnt vmcnt(4)
L_F247:
    s_waitcnt vmcnt(6)
    buffer_load_dwordx4 v[212:215], v2, s[8:11], s65 offen nt
    s_addk_i32 s65, 0x1000
    s_and_b32 s65, s65, s66
    v_mov_b32 v249, 248
    ds_write_b32 v248, v249
    ds_read_b32 v250, v248 offset:1024
    s_cbranch_vccnz L_F248
    s_waitcnt vmcnt(4)
L_F248:
    s_waitcnt vmcnt(6)
    buffer_load_dwordx4 v[216:219], v2, s[8:11], s65 offen nt
    s_addk_i32 s65, 0x1000
    s_and_b32 s65, s65, s66
    v_perm_b32 v88, v188, v184, s69
    v_perm_b32 v92, v188, v184, s70
    v_perm_b32 v96, v189, v185, s69
    v_perm_b32 v100, v189, v185, s70
    v_perm_b32 v104, v190, v186, s69
    v_perm_b32 v108, v190, v186, s70
    v_perm_b32 v112, v191, v187, s69
    v_perm_b32 v116, v191, v187, s70
    s_waitcnt lgkmcnt(0)
    v_cmp_lt_i32 vcc, v249, v250
    s_cbranch_vccnz L_F249
    s_waitcnt vmcnt(4)
L_F249:
    s_waitcnt vmcnt(6)
    buffer_load_dwordx4 v[220:223], v2, s[8:11], s65 offen nt
    s_addk_i32 s65, 0x1000
    s_and_b32 s65, s65, s66
    s_cbranch_vccnz L_F250
    s_waitcnt vmcnt(4)
L_F250:
    s_waitcnt vmcnt(6)
    buffer_load_dwordx4 v[224:227], v2, s[8:11], s65 offen nt
    s_addk_i32 s65, 0x1000
    s_and_b32 s65, s65, s66
    v_perm_b32 v89, v196, v192, s69
    v_perm_b32 v93, v196, v192, s70
    v_perm_b32 v97, v197, v193, s69
    v_perm_b32 v101, v197, v193, s70
    v_perm_b32 v105, v198, v194, s69
    v_perm_b32 v109, v198, v194, s70
    v_perm_b32 v113, v199, v195, s69
    v_perm_b32 v117, v199, v195, s70
    s_cbranch_vccnz L_F251
    s_waitcnt vmcnt(4)
L_F251:
    s_waitcnt vmcnt(6)
    buffer_load_dwordx4 v[228:231], v2, s[8:11], s65 offen nt
    s_addk_i32 s65, 0x1000
    s_and_b32 s65, s65, s66
    v_mov_b32 v249, 252
    ds_write_b32 v248, v249
    ds_read_b32 v250, v248 offset:1024
    s_cbranch_vccnz L_F252
    s_waitcnt vmcnt(4)
L_F252:
    s_waitcnt vmcnt(6)
    buffer_load_dwordx4 v[232:235], v2, s[8:11], s65 offen nt
    s_addk_i32 s65, 0x1000
    s_and_b32 s65, s65, s66
    v_perm_b32 v90, v204, v200, s69
    v_perm_b32 v94, v204, v200, s70
    v_perm_b32 v98, v205, v201, s69
    v_perm_b32 v102, v205, v201, s70
    v_perm_b32 v106, v206, v202, s69
    v_perm_b32 v110, v206, v202, s70
    v_perm_b32 v114, v207, v203, s69
    v_perm_b32 v118, v207, v203, s70
    s_waitcnt lgkmcnt(0)
    v_cmp_lt_i32 vcc, v249, v250
    s_cbranch_vccnz L_F253
    s_waitcnt vmcnt(4)
L_F253:
    s_waitcnt vmcnt(6)
    buffer_load_dwordx4 v[236:239], v2, s[8:11], s65 offen nt
    s_addk_i32 s65, 0x1000
    s_and_b32 s65, s65, s66
    s_cbranch_vccnz L_F254
    s_waitcnt vmcnt(4)
L_F254:
    s_waitcnt vmcnt(6)
    buffer_load_dwordx4 v[240:243], v2, s[8:11], s65 offen nt
    s_addk_i32 s65, 0x1000
    s_and_b32 s65, s65, s66
    v_perm_b32 v91, v212, v208, s69
    v_perm_b32 v95, v212, v208, s70
    v_perm_b32 v99, v213, v209, s69
    v_perm_b32 v103, v213, v209, s70
    v_perm_b32 v107, v214, v210, s69
    v_perm_b32 v111, v214, v210, s70
    v_perm_b32 v115, v215, v211, s69
    v_perm_b32 v119, v215, v211, s70
    v_mfma_f32_16x16x32_bf16 v[64:67], v[48:51], v[88:91], v[64:67]
    v_mfma_f32_16x16x32_bf16 v[64:67], v[52:55], v[92:95], v[64:67]
    v_mfma_f32_16x16x32_bf16 v[64:67], v[56:59], v[96:99], v[64:67]
    v_mfma_f32_16x16x32_bf16 v[64:67], v[60:63], v[100:103], v[64:67]
    v_mfma_f32_16x16x32_bf16 v[68:71], v[48:51], v[104:107], v[68:71]
    v_mfma_f32_16x16x32_bf16 v[68:71], v[52:55], v[108:111], v[68:71]
    v_mfma_f32_16x16x32_bf16 v[68:71], v[56:59], v[112:115], v[68:71]
    v_mfma_f32_16x16x32_bf16 v[68:71], v[60:63], v[116:119], v[68:71]
    v_and_b32_dpp v48, v40, v8 quad_perm:[3,3,3,3] row_mask:0xf bank_mask:0xf
    v_and_b32_dpp v49, v41, v8 quad_perm:[3,3,3,3] row_mask:0xf bank_mask:0xf
    v_and_b32_dpp v50, v42, v8 quad_perm:[3,3,3,3] row_mask:0xf bank_mask:0xf
    v_and_b32_dpp v51, v43, v8 quad_perm:[3,3,3,3] row_mask:0xf bank_mask:0xf
    v_and_b32_dpp v52, v40, v9 quad_perm:[3,3,3,3] row_mask:0xf bank_mask:0xf
    v_and_b32_dpp v53, v41, v9 quad_perm:[3,3,3,3] row_mask:0xf bank_mask:0xf
    v_and_b32_dpp v54, v42, v9 quad_perm:[3,3,3,3] row_mask:0xf bank_mask:0xf
    v_and_b32_dpp v55, v43, v9 quad_perm:[3,3,3,3] row_mask:0xf bank_mask:0xf
    v_and_b32_dpp v56, v40, v10 quad_perm:[3,3,3,3] row_mask:0xf bank_mask:0xf
    v_and_b32_dpp v57, v41, v10 quad_perm:[3,3,3,3] row_mask:0xf bank_mask:0xf
    v_and_b32_dpp v58, v42, v10 quad_perm:[3,3,3,3] row_mask:0xf bank_mask:0xf
    v_and_b32_dpp v59, v43, v10 quad_perm:[3,3,3,3] row_mask:0xf bank_mask:0xf
    v_and_b32_dpp v60, v40, v11 quad_perm:[3,3,3,3] row_mask:0xf bank_mask:0xf
    v_and_b32_dpp v61, v41, v11 quad_perm:[3,3,3,3] row_mask:0xf bank_mask:0xf
    v_and_b32_dpp v62, v42, v11 quad_perm:[3,3,3,3] row_mask:0xf bank_mask:0xf
    v_and_b32_dpp v63, v43, v11 quad_perm:[3,3,3,3] row_mask:0xf bank_mask:0xf
    s_cbranch_vccnz L_F255
    s_waitcnt vmcnt(4)
L_F255:
    s_waitcnt vmcnt(6)
    buffer_load_dwordx4 v[244:247], v2, s[8:11], s65 offen nt
    s_addk_i32 s65, 0x1000
    s_and_b32 s65, s65, s66
    s_lshl_b32 s81, s3, 4
    s_add_u32 s81, s81, 150976
    v_mov_b32 v7, s81
    s_waitcnt vmcnt(6)
    v_perm_b32 v88, v220, v216, s69
    v_perm_b32 v92, v220, v216, s70
    v_perm_b32 v96, v221, v217, s69
    v_perm_b32 v100, v221, v217, s70
    v_perm_b32 v104, v222, v218, s69
    v_perm_b32 v108, v222, v218, s70
    v_perm_b32 v112, v223, v219, s69
    v_perm_b32 v116, v223, v219, s70
    s_waitcnt vmcnt(4)
    v_perm_b32 v89, v228, v224, s69
    v_perm_b32 v93, v228, v224, s70
    v_perm_b32 v97, v229, v225, s69
    v_perm_b32 v101, v229, v225, s70
    v_perm_b32 v105, v230, v226, s69
    v_perm_b32 v109, v230, v226, s70
    v_perm_b32 v113, v231, v227, s69
    v_perm_b32 v117, v231, v227, s70
    s_waitcnt vmcnt(3)
    s_movk_i32 s81, 0
    buffer_load_dwordx4 v[120:123], v1, s[16:19], s81 offen nt
    s_waitcnt vmcnt(3)
    s_movk_i32 s81, 4096
    buffer_load_dwordx4 v[124:127], v1, s[16:19], s81 offen nt
    v_perm_b32 v90, v236, v232, s69
    v_perm_b32 v94, v236, v232, s70
    v_perm_b32 v98, v237, v233, s69
    v_perm_b32 v102, v237, v233, s70
    v_perm_b32 v106, v238, v234, s69
    v_perm_b32 v110, v238, v234, s70
    v_perm_b32 v114, v239, v235, s69
    v_perm_b32 v118, v239, v235, s70
    s_waitcnt vmcnt(3)
    s_movk_i32 s81, 8192
    buffer_load_dwordx4 v[128:131], v1, s[16:19], s81 offen nt
    s_waitcnt vmcnt(3)
    s_movk_i32 s81, 12288
    buffer_load_dwordx4 v[132:135], v1, s[16:19], s81 offen nt
    s_movk_i32 s81, 0
    buffer_load_dwordx4 v[136:139], v251, s[4:7], s81 offen nt
    s_movk_i32 s81, 8192
    buffer_load_dwordx4 v[140:143], v251, s[4:7], s81 offen nt
    v_perm_b32 v91, v244, v240, s69
    v_perm_b32 v107, v246, v242, s69
    v_perm_b32 v95, v244, v240, s70
    v_mfma_f32_16x16x32_bf16 v[64:67], v[48:51], v[88:91], v[64:67]
    v_perm_b32 v111, v246, v242, s70
    v_mfma_f32_16x16x32_bf16 v[68:71], v[48:51], v[104:107], v[68:71]
    v_perm_b32 v99, v245, v241, s69
    v_mfma_f32_16x16x32_bf16 v[64:67], v[52:55], v[92:95], v[64:67]
    v_perm_b32 v115, v247, v243, s69
    v_mfma_f32_16x16x32_bf16 v[68:71], v[52:55], v[108:111], v[68:71]
    v_perm_b32 v103, v245, v241, s70
    v_mfma_f32_16x16x32_bf16 v[64:67], v[56:59], v[96:99], v[64:67]
    v_perm_b32 v119, v247, v243, s70
    v_mfma_f32_16x16x32_bf16 v[68:71], v[56:59], v[112:115], v[68:71]
    v_mfma_f32_16x16x32_bf16 v[64:67], v[60:63], v[100:103], v[64:67]
    v_mfma_f32_16x16x32_bf16 v[68:71], v[60:63], v[116:119], v[68:71]
    s_nop 6
    ds_write_b128 v3, v[64:67]
    ds_write_b128 v3, v[68:71] offset:1024
    s_waitcnt lgkmcnt(0)
    s_barrier
    s_mov_b32 exec_lo, -1
    s_mov_b32 exec_hi, 0
    ds_read_b32 v15, v7 offset:640
    ds_read_b128 v[16:19], v7
    ds_read_b128 v[20:23], v4 offset:0
    ds_read_b128 v[24:27], v4 offset:37440
    v_add_u32 v14, 74880, v4
    ds_read_b128 v[28:31], v14 offset:0
    ds_read_b128 v[32:35], v14 offset:37440
    s_waitcnt lgkmcnt(3)
    v_readfirstlane_b32 s67, v15
    v_pk_mul_f32 v[20:21], v[16:17], v[20:21] op_sel_hi:[0,1]
    v_pk_mul_f32 v[22:23], v[16:17], v[22:23] op_sel_hi:[0,1]
    s_waitcnt lgkmcnt(2)
    v_pk_fma_f32 v[20:21], v[16:17], v[24:25], v[20:21] op_sel:[1,0,0] op_sel_hi:[1,1,1]
    v_pk_fma_f32 v[22:23], v[16:17], v[26:27], v[22:23] op_sel:[1,0,0] op_sel_hi:[1,1,1]
    s_waitcnt lgkmcnt(1)
    v_pk_fma_f32 v[20:21], v[18:19], v[28:29], v[20:21] op_sel:[0,0,0] op_sel_hi:[0,1,1]
    v_pk_fma_f32 v[22:23], v[18:19], v[30:31], v[22:23] op_sel:[0,0,0] op_sel_hi:[0,1,1]
    s_waitcnt lgkmcnt(0)
    v_pk_fma_f32 v[20:21], v[18:19], v[32:33], v[20:21] op_sel:[1,0,0] op_sel_hi:[1,1,1]
    v_pk_fma_f32 v[22:23], v[18:19], v[34:35], v[22:23] op_sel:[1,0,0] op_sel_hi:[1,1,1]
    s_cmp_eq_u32 s67, 0
    v_and_or_b32 v20, v20, -16, v80
    v_and_or_b32 v21, v21, -16, v81
    v_and_or_b32 v22, v22, -16, v82
    v_and_or_b32 v23, v23, -16, v83
    s_cbranch_scc1 L_ST1X
    buffer_store_dwordx4 v[20:23], v5, s[12:15], 0 offen
L_ST1D:
    s_mov_b64 exec, -1
    ds_read_b32 v18, v252
    v_mov_b32 v19, 0
    buffer_load_dwordx4 v[24:27], v6, s[12:15], 0 offen sc1
    buffer_load_dwordx4 v[28:31], v6, s[12:15], s29 offen sc1
    v_lshlrev_b32 v3, 5, v0
    s_add_u32 s81, s68, 4096
    v_add_u32 v3, s81, v3
    v_lshrrev_b32 v14, 3, v0
    v_lshlrev_b32 v4, 7, v14
    v_and_b32 v15, 3, v0
    v_lshl_add_u32 v4, v15, 5, v4
    v_bfe_u32 v14, v0, 2, 1
    v_lshl_add_u32 v4, v14, 4, v4
    s_and_b32 s81, s34, 3
    s_lshl_b32 s81, s81, 15
    s_lshl_b32 s82, s33, 3
    s_lshr_b32 s83, s34, 2
    s_add_u32 s82, s82, s83
    s_lshl_b32 s82, s82, 9
    s_add_u32 s81, s81, s82
    s_add_u32 s81, s81, 524288
    v_lshl_add_u32 v1, v0, 4, s81
    v_add_u32 v2, 74880, v4
    s_and_b32 s81, s62, 1
    s_lshl_b32 s81, s81, 4
    s_lshl_b32 s81, 0xffff, s81
    s_and_b32 s67, s67, s81
    s_lshr_b32 s81, s62, 1
    s_and_b32 s82, s63, 3
    s_cmp_eq_u32 s81, s82
    s_cselect_b32 s67, s67, 0
    v_mov_b32 v91, 0
    v_mov_b32 v95, 0
    v_mov_b32 v99, 0
    v_mov_b32 v103, 0
    v_mov_b32 v107, 0
    v_mov_b32 v111, 0
    v_mov_b32 v115, 0
    v_mov_b32 v119, 0
    s_waitcnt vmcnt(7) lgkmcnt(0)
    v_perm_b32 v88, v124, v120, s69
    v_perm_b32 v92, v124, v120, s70
    v_perm_b32 v96, v125, v121, s69
    v_perm_b32 v100, v125, v121, s70
    v_perm_b32 v104, v126, v122, s69
    v_perm_b32 v108, v126, v122, s70
    v_perm_b32 v112, v127, v123, s69
    v_perm_b32 v116, v127, v123, s70
    s_waitcnt vmcnt(5) lgkmcnt(0)
    v_perm_b32 v89, v132, v128, s69
    v_perm_b32 v93, v132, v128, s70
    v_perm_b32 v97, v133, v129, s69
    v_perm_b32 v101, v133, v129, s70
    v_perm_b32 v105, v134, v130, s69
    v_perm_b32 v109, v134, v130, s70
    v_perm_b32 v113, v135, v131, s69
    v_perm_b32 v117, v135, v131, s70
    s_waitcnt vmcnt(3) lgkmcnt(0)
    v_perm_b32 v90, v140, v136, s69
    v_perm_b32 v94, v140, v136, s70
    v_perm_b32 v98, v141, v137, s69
    v_perm_b32 v102, v141, v137, s70
    v_perm_b32 v106, v142, v138, s69
    v_perm_b32 v110, v142, v138, s70
    v_perm_b32 v114, v143, v139, s69
    v_perm_b32 v118, v143, v139, s70
    s_branch L_P1CHK
L_P1:
    buffer_load_dwordx4 v[24:27], v6, s[12:15], 0 offen sc1
    buffer_load_dwordx4 v[28:31], v6, s[12:15], s29 offen sc1
L_P1CHK:
    s_waitcnt vmcnt(0)
    v_xor_b32 v24, v80, v24
    v_xor_b32 v25, v81, v25
    v_xor_b32 v26, v82, v26
    v_xor_b32 v27, v83, v27
    v_xor_b32 v28, v80, v28
    v_xor_b32 v29, v81, v29
    v_xor_b32 v30, v82, v30
    v_xor_b32 v31, v83, v31
    v_or3_b32 v14, v24, v25, v26
    v_or3_b32 v14, v14, v27, v28
    v_or3_b32 v14, v14, v29, v30
    v_or_b32 v14, v14, v31
    v_and_b32 v14, 15, v14
    v_cmp_ne_u32 vcc, 0, v14
    s_wqm_b64 exec, vcc
    s_sub_u32 s80, s80, 1
    s_cbranch_scc1 L_EXIT
    s_cbranch_vccnz L_P1
    s_mov_b64 exec, -1
    v_pk_add_f32 v[24:25], v[24:25], v[28:29]
    v_pk_add_f32 v[26:27], v[26:27], v[30:31]
    s_nop 1
    v_permlane32_swap_b32 v24, v26
    v_permlane32_swap_b32 v25, v27
    v_add_f32 v24, v24, v26
    v_add_f32 v25, v25, v27
    s_nop 1
    v_permlane16_swap_b32 v24, v25
    v_add_f32 v24, v24, v25
    s_nop 1
    v_add_f32_dpp v24, v24, v24 row_ror:4 row_mask:0xf bank_mask:0xf
    s_nop 1
    v_add_f32_dpp v24, v24, v24 row_ror:8 row_mask:0xf bank_mask:0xf
    s_nop 1
    v_mov_b32_dpp v28, v24 quad_perm:[0,0,0,0] row_mask:0xf bank_mask:0xf
    v_mov_b32_dpp v29, v24 quad_perm:[1,1,1,1] row_mask:0xf bank_mask:0xf
    v_mov_b32_dpp v30, v24 quad_perm:[2,2,2,2] row_mask:0xf bank_mask:0xf
    v_mov_b32_dpp v31, v24 quad_perm:[3,3,3,3] row_mask:0xf bank_mask:0xf
    v_cvt_pk_bf16_f32 v16, v28, v29
    v_cvt_pk_bf16_f32 v17, v30, v31
    s_nop 1
    v_mfma_f32_16x16x32_bf16 v[32:35], v[16:19], v[88:91], 0
    v_mfma_f32_16x16x32_bf16 v[36:39], v[16:19], v[92:95], 0
    v_mfma_f32_16x16x32_bf16 v[40:43], v[16:19], v[96:99], 0
    v_mfma_f32_16x16x32_bf16 v[44:47], v[16:19], v[100:103], 0
    v_mfma_f32_16x16x32_bf16 v[48:51], v[16:19], v[104:107], 0
    v_mfma_f32_16x16x32_bf16 v[52:55], v[16:19], v[108:111], 0
    v_mfma_f32_16x16x32_bf16 v[56:59], v[16:19], v[112:115], 0
    v_mfma_f32_16x16x32_bf16 v[60:63], v[16:19], v[116:119], 0
    s_mov_b64 exec, 0xffff
    s_nop 0
    ds_write2_b32 v3, v32, v36 offset0:0 offset1:1
    s_nop 0
    ds_write2_b32 v3, v40, v44 offset0:2 offset1:3
    s_nop 0
    ds_write2_b32 v3, v48, v52 offset0:4 offset1:5
    s_nop 0
    ds_write2_b32 v3, v56, v60 offset0:6 offset1:7
    s_waitcnt lgkmcnt(0)
    s_barrier
    s_cmp_lg_u32 s3, 0
    s_cbranch_scc1 L_FINAL
    s_mov_b32 exec_lo, -1
    s_mov_b32 exec_hi, 0
    ds_read_b128 v[20:23], v4 offset:4096
    ds_read_b128 v[24:27], v4 offset:41536
    ds_read_b128 v[28:31], v2 offset:4096
    ds_read_b128 v[32:35], v2 offset:41536
    s_waitcnt lgkmcnt(2)
    v_pk_add_f32 v[20:21], v[20:21], v[24:25]
    v_pk_add_f32 v[22:23], v[22:23], v[26:27]
    s_waitcnt lgkmcnt(1)
    v_pk_add_f32 v[20:21], v[20:21], v[28:29]
    v_pk_add_f32 v[22:23], v[22:23], v[30:31]
    s_waitcnt lgkmcnt(0)
    v_pk_add_f32 v[20:21], v[20:21], v[32:33]
    v_pk_add_f32 v[22:23], v[22:23], v[34:35]
    v_and_or_b32 v20, v20, -16, v80
    v_and_or_b32 v21, v21, -16, v81
    v_and_or_b32 v22, v22, -16, v82
    v_and_or_b32 v23, v23, -16, v83
    s_not_b32 exec_lo, s67
    buffer_store_dwordx4 v[20:23], v1, s[12:15], 0 offen sc1
    s_cmp_eq_u32 s67, 0
    s_cbranch_scc1 L_EXIT
    s_mov_b32 exec_lo, s67
    buffer_store_dwordx4 v[20:23], v1, s[12:15], 0 offen
    s_branch L_EXIT
L_ST1X:
    buffer_store_dwordx4 v[20:23], v5, s[12:15], 0 offen sc1
    s_branch L_ST1D
L_FINAL:
L_IW0:
    s_cbranch_execz L_IW1
    s_cmp_lg_u32 s3, 1
    s_cbranch_scc1 L_EXIT
    s_cmp_lt_u32 s2, 224
    s_cbranch_scc1 L_EXIT
    s_mov_b64 exec, -1
    s_add_u32 s35, s2, 8
    s_and_b32 s35, s35, 7
    s_lshl_b32 s35, s35, 2
    s_bfe_u32 s82, s2, 0x20003
    s_add_u32 s35, s35, s82
    s_lshr_b32 s82, s35, 1
    s_lshl_b32 s82, s82, 6
L_IW1:
    s_cbranch_execz L_IW2
    s_and_b32 s83, s35, 1
    s_lshl_b32 s83, s83, 3
    s_add_u32 s82, s82, s83
    s_lshl_b32 s29, s35, 12
    s_add_u32 s29, s29, 524288
    v_lshlrev_b32 v6, 4, v0
    v_lshlrev_b32 v7, 2, v0
    v_add_u32 v7, 151040, v7
    ds_read_b32 v16, v7
    v_lshrrev_b32 v14, 4, v0
    v_lshlrev_b32 v14, 1, v14
    v_lshl_add_u32 v5, v15, 4, v14
L_IW2:
    s_cbranch_execz L_IW3
    s_lshr_b32 s29, s35, 3
    s_lshl_b32 s29, s29, 15
    s_and_b32 s83, s35, 7
    s_lshl_b32 s83, s83, 6
    s_add_u32 s29, s29, s83
    s_add_u32 s29, s29, 524288
    v_lshrrev_b32 v6, 2, v0
    v_lshlrev_b32 v6, 9, v6
    v_lshl_add_u32 v6, v15, 4, v6
    s_add_u32 s26, s29, 8192
    s_add_u32 s27, s29, 16384
L_IW3:
    s_cbranch_execz L_IW4
    s_add_u32 s81, s29, 24576
    buffer_load_dwordx4 v[176:179], v6, s[12:15], s29 offen sc1
    buffer_load_dwordx4 v[180:183], v6, s[12:15], s26 offen sc1
    buffer_load_dwordx4 v[184:187], v6, s[12:15], s27 offen sc1
    buffer_load_dwordx4 v[188:191], v6, s[12:15], s81 offen sc1
    buffer_load_dwordx4 v[192:195], v6, s[12:15], s29 offen sc1
    buffer_load_dwordx4 v[196:199], v6, s[12:15], s26 offen sc1
L_IW4:
    s_cbranch_execz L_IW5
    buffer_load_dwordx4 v[200:203], v6, s[12:15], s27 offen sc1
    buffer_load_dwordx4 v[204:207], v6, s[12:15], s81 offen sc1
    s_mov_b64 s[24:25], -1
L_P2:
    s_waitcnt vmcnt(4)
    v_xor_b32 v176, v80, v176
    v_xor_b32 v177, v81, v177
    v_xor_b32 v178, v82, v178
    v_xor_b32 v179, v83, v179
    v_xor_b32 v180, v80, v180
    v_xor_b32 v181, v81, v181
    v_xor_b32 v182, v82, v182
    v_xor_b32 v183, v83, v183
L_IW5:
    s_cbranch_execz L_IW6
    v_xor_b32 v184, v80, v184
    v_xor_b32 v185, v81, v185
    v_xor_b32 v186, v82, v186
    v_xor_b32 v187, v83, v187
    v_xor_b32 v188, v80, v188
    v_xor_b32 v189, v81, v189
    v_xor_b32 v190, v82, v190
    v_xor_b32 v191, v83, v191
    v_or3_b32 v14, v176, v177, v178
    v_or3_b32 v14, v14, v179, v180
    v_or3_b32 v14, v14, v181, v182
L_IW6:
    s_cbranch_execz L_IW7
    v_or3_b32 v14, v14, v183, v184
    v_or3_b32 v14, v14, v185, v186
    v_or3_b32 v14, v14, v187, v188
    v_or3_b32 v14, v14, v189, v190
    v_or_b32 v14, v14, v191
    v_and_b32 v14, 15, v14
    v_cmp_ne_u32 vcc, 0, v14
    s_wqm_b64 exec, vcc
    s_cbranch_vccz L_P2D0
    buffer_load_dwordx4 v[176:179], v6, s[12:15], s29 offen sc1
    buffer_load_dwordx4 v[180:183], v6, s[12:15], s26 offen sc1
    buffer_load_dwordx4 v[184:187], v6, s[12:15], s27 offen sc1
    buffer_load_dwordx4 v[188:191], v6, s[12:15], s81 offen sc1
    s_andn2_b64 exec, s[24:25], exec
    s_andn2_b64 s[24:25], s[24:25], exec
    v_pk_add_f32 v[176:177], v[176:177], v[184:185]
    v_pk_add_f32 v[178:179], v[178:179], v[186:187]
    v_pk_add_f32 v[180:181], v[180:181], v[188:189]
    v_pk_add_f32 v[182:183], v[182:183], v[190:191]
    v_pk_add_f32 v[24:25], v[176:177], v[180:181]
    v_pk_add_f32 v[26:27], v[178:179], v[182:183]
    s_mov_b64 exec, s[24:25]
L_IW7:
    s_cbranch_execz L_IW8
    s_waitcnt vmcnt(4)
    v_xor_b32 v192, v80, v192
    v_xor_b32 v193, v81, v193
    v_xor_b32 v194, v82, v194
    v_xor_b32 v195, v83, v195
    v_xor_b32 v196, v80, v196
    v_xor_b32 v197, v81, v197
    v_xor_b32 v198, v82, v198
    v_xor_b32 v199, v83, v199
    v_xor_b32 v200, v80, v200
    v_xor_b32 v201, v81, v201
    v_xor_b32 v202, v82, v202
    v_xor_b32 v203, v83, v203
    v_xor_b32 v204, v80, v204
L_IW8:
    s_cbranch_execz L_IW9
    v_xor_b32 v205, v81, v205
    v_xor_b32 v206, v82, v206
    v_xor_b32 v207, v83, v207
    v_or3_b32 v14, v192, v193, v194
    v_or3_b32 v14, v14, v195, v196
    v_or3_b32 v14, v14, v197, v198
    v_or3_b32 v14, v14, v199, v200
    v_or3_b32 v14, v14, v201, v202
    v_or3_b32 v14, v14, v203, v204
L_IW9:
    s_cbranch_execz L_IW10
    v_or3_b32 v14, v14, v205, v206
    v_or_b32 v14, v14, v207
    v_and_b32 v14, 15, v14
    v_cmp_ne_u32 vcc, 0, v14
    s_wqm_b64 exec, vcc
    s_cbranch_vccz L_P2D1
    buffer_load_dwordx4 v[192:195], v6, s[12:15], s29 offen sc1
    buffer_load_dwordx4 v[196:199], v6, s[12:15], s26 offen sc1
    buffer_load_dwordx4 v[200:203], v6, s[12:15], s27 offen sc1
    buffer_load_dwordx4 v[204:207], v6, s[12:15], s81 offen sc1
    s_andn2_b64 exec, s[24:25], exec
    s_andn2_b64 s[24:25], s[24:25], exec
    v_pk_add_f32 v[192:193], v[192:193], v[200:201]
    v_pk_add_f32 v[194:195], v[194:195], v[202:203]
    v_pk_add_f32 v[196:197], v[196:197], v[204:205]
    v_pk_add_f32 v[198:199], v[198:199], v[206:207]
    v_pk_add_f32 v[24:25], v[192:193], v[196:197]
    v_pk_add_f32 v[26:27], v[194:195], v[198:199]
    s_mov_b64 exec, s[24:25]
L_IW10:
    s_cbranch_execz L_IW11
    s_sub_u32 s80, s80, 1
    s_cbranch_scc0 L_P2
    s_branch L_EXIT
L_P2D0:
    s_mov_b64 exec, s[24:25]
    v_pk_add_f32 v[176:177], v[176:177], v[184:185]
    v_pk_add_f32 v[178:179], v[178:179], v[186:187]
    v_pk_add_f32 v[180:181], v[180:181], v[188:189]
    v_pk_add_f32 v[182:183], v[182:183], v[190:191]
    v_pk_add_f32 v[24:25], v[176:177], v[180:181]
L_IW11:
    s_cbranch_execz L_IW12
    v_pk_add_f32 v[26:27], v[178:179], v[182:183]
    s_branch L_P2E
L_P2D1:
    s_mov_b64 exec, s[24:25]
    v_pk_add_f32 v[192:193], v[192:193], v[200:201]
    v_pk_add_f32 v[194:195], v[194:195], v[202:203]
    v_pk_add_f32 v[196:197], v[196:197], v[204:205]
    v_pk_add_f32 v[198:199], v[198:199], v[206:207]
    v_pk_add_f32 v[24:25], v[192:193], v[196:197]
L_IW12:
    s_cbranch_execz L_IW13
    v_pk_add_f32 v[26:27], v[194:195], v[198:199]
L_P2E:
    s_mov_b64 exec, -1
    s_nop 0
    v_permlane32_swap_b32 v24, v26
    v_permlane32_swap_b32 v25, v27
    v_add_f32 v24, v24, v26
    v_add_f32 v25, v25, v27
    s_nop 1
    v_permlane16_swap_b32 v24, v25
    v_add_f32 v24, v24, v25
    s_nop 1
    v_add_f32_dpp v24, v24, v24 row_ror:4 row_mask:0xf bank_mask:0xf
L_IW13:
    s_cbranch_execz L_IW14
    s_nop 1
    v_add_f32_dpp v24, v24, v24 row_ror:8 row_mask:0xf bank_mask:0xf
    s_waitcnt lgkmcnt(0)
    v_add_f32 v24, v16, v24
    v_cvt_pk_bf16_f32 v24, v24, v24
    s_mov_b32 exec_lo, 0x000f000f
    s_mov_b32 exec_hi, 0x000f000f
    buffer_store_short v24, v5, s[20:23], s82 offen
    s_cmp_lg_u32 s2, 224
L_IW14:
    s_cbranch_execz L_IW15
    s_cbranch_scc1 L_NOE
    s_mov_b64 exec, 1
    v_mov_b32 v24, s28
    v_mov_b32 v5, 1146880
    buffer_store_dword v24, v5, s[12:15], 0 offen
L_NOE:
L_EXIT:
    s_waitcnt vmcnt(0)
    s_endpgm
L_HELP:
    s_mov_b32 s12, s60
    s_mov_b32 s13, s61
    s_mov_b32 s14, 4194304
    s_mov_b32 s15, 0x20000
    s_add_u32 s30, s60, 1146880
    s_addc_u32 s31, s61, 0
    s_load_dword s28, s[30:31], 0
    v_mov_b32 v160, -1
    v_mov_b32 v161, -1
    v_lshrrev_b32 v7, 4, v0
    v_lshlrev_b32 v6, 3, v0
    v_add_u32 v6, 150784, v6
    s_mov_b64 exec, 0x1ffff
    ds_write_b64 v6, v[160:161]
    s_mov_b64 exec, -1
    s_waitcnt vmcnt(19)
    v_lshlrev_b32 v168, 16, v8
    v_and_b32 v169, 0xffff0000, v8
    v_lshlrev_b32 v170, 16, v9
    v_and_b32 v171, 0xffff0000, v9
    v_lshlrev_b32 v172, 16, v10
    v_and_b32 v173, 0xffff0000, v10
    v_lshlrev_b32 v174, 16, v11
    v_and_b32 v175, 0xffff0000, v11
    v_add_f32 v200, v168, v169
    v_add_f32 v200, v200, v170
    v_add_f32 v200, v200, v171
    v_add_f32 v200, v200, v172
    v_add_f32 v200, v200, v173
    v_add_f32 v200, v200, v174
    v_add_f32 v200, v200, v175
    s_nop 1
    v_add_f32_dpp v200, v200, v200 row_ror:1 row_mask:0xf bank_mask:0xf
    s_nop 1
    v_add_f32_dpp v200, v200, v200 row_ror:2 row_mask:0xf bank_mask:0xf
    s_nop 1
    v_add_f32_dpp v200, v200, v200 row_ror:4 row_mask:0xf bank_mask:0xf
    s_nop 1
    v_add_f32_dpp v200, v200, v200 row_ror:8 row_mask:0xf bank_mask:0xf
    v_mov_b32 v202, v200
    s_nop 1
    v_permlane16_swap_b32 v202, v200
    v_add_f32 v200, v202, v200
    v_mov_b32 v202, v200
    s_nop 1
    v_permlane32_swap_b32 v202, v200
    v_add_f32 v200, v202, v200
    v_mul_f32 v200, 0x3b000000, v200
    v_sub_f32 v168, v168, v200
    v_sub_f32 v169, v169, v200
    v_sub_f32 v170, v170, v200
    v_sub_f32 v171, v171, v200
    v_sub_f32 v172, v172, v200
    v_sub_f32 v173, v173, v200
    v_sub_f32 v174, v174, v200
    v_sub_f32 v175, v175, v200
    v_mul_f32 v201, v168, v168
    v_fmac_f32 v201, v169, v169
    v_fmac_f32 v201, v170, v170
    v_fmac_f32 v201, v171, v171
    v_fmac_f32 v201, v172, v172
    v_fmac_f32 v201, v173, v173
    v_fmac_f32 v201, v174, v174
    v_fmac_f32 v201, v175, v175
    s_nop 1
    v_add_f32_dpp v201, v201, v201 row_ror:1 row_mask:0xf bank_mask:0xf
    s_nop 1
    v_add_f32_dpp v201, v201, v201 row_ror:2 row_mask:0xf bank_mask:0xf
    s_nop 1
    v_add_f32_dpp v201, v201, v201 row_ror:4 row_mask:0xf bank_mask:0xf
    s_nop 1
    v_add_f32_dpp v201, v201, v201 row_ror:8 row_mask:0xf bank_mask:0xf
    v_mov_b32 v202, v201
    s_nop 1
    v_permlane16_swap_b32 v202, v201
    v_add_f32 v201, v202, v201
    v_mov_b32 v202, v201
    s_nop 1
    v_permlane32_swap_b32 v202, v201
    v_add_f32 v201, v202, v201
    v_mul_f32 v201, 0x3b000000, v201
    v_cvt_pk_bf16_f32 v200, v200, v200
    v_and_b32 v200, 0xffff0000, v200
    v_cvt_pk_bf16_f32 v201, v201, v201
    v_and_b32 v201, 0xffff0000, v201
    v_add_f32 v201, 0x3727c5ac, v201
    v_cvt_pk_bf16_f32 v201, v201, v201
    v_and_b32 v201, 0xffff0000, v201
    v_sqrt_f32 v201, v201
    s_nop 0
    v_cvt_pk_bf16_f32 v201, v201, v201
    v_and_b32 v201, 0xffff0000, v201
    v_rcp_f32 v201, v201
    s_waitcnt vmcnt(16) lgkmcnt(0)
    v_lshlrev_b32 v168, 16, v12
    v_and_b32 v169, 0xffff0000, v12
    v_lshlrev_b32 v170, 16, v13
    v_and_b32 v171, 0xffff0000, v13
    v_lshlrev_b32 v172, 16, v14
    v_and_b32 v173, 0xffff0000, v14
    v_lshlrev_b32 v174, 16, v15
    v_and_b32 v175, 0xffff0000, v15
    v_lshlrev_b32 v176, 16, v16
    v_and_b32 v177, 0xffff0000, v16
    v_lshlrev_b32 v178, 16, v17
    v_and_b32 v179, 0xffff0000, v17
    v_lshlrev_b32 v180, 16, v18
    v_and_b32 v181, 0xffff0000, v18
    v_lshlrev_b32 v182, 16, v19
    v_and_b32 v183, 0xffff0000, v19
    v_sub_f32 v168, v168, v200
    v_sub_f32 v169, v169, v200
    v_sub_f32 v170, v170, v200
    v_sub_f32 v171, v171, v200
    v_sub_f32 v172, v172, v200
    v_sub_f32 v173, v173, v200
    v_sub_f32 v174, v174, v200
    v_sub_f32 v175, v175, v200
    v_sub_f32 v176, v176, v200
    v_sub_f32 v177, v177, v200
    v_sub_f32 v178, v178, v200
    v_sub_f32 v179, v179, v200
    v_sub_f32 v180, v180, v200
    v_sub_f32 v181, v181, v200
    v_sub_f32 v182, v182, v200
    v_sub_f32 v183, v183, v200
    v_cvt_pk_bf16_f32 v12, v168, v169
    v_cvt_pk_bf16_f32 v13, v170, v171
    v_cvt_pk_bf16_f32 v14, v172, v173
    v_cvt_pk_bf16_f32 v15, v174, v175
    v_cvt_pk_bf16_f32 v16, v176, v177
    v_cvt_pk_bf16_f32 v17, v178, v179
    v_cvt_pk_bf16_f32 v18, v180, v181
    v_cvt_pk_bf16_f32 v19, v182, v183
    v_lshlrev_b32 v168, 16, v12
    v_and_b32 v169, 0xffff0000, v12
    v_lshlrev_b32 v170, 16, v13
    v_and_b32 v171, 0xffff0000, v13
    v_lshlrev_b32 v172, 16, v14
    v_and_b32 v173, 0xffff0000, v14
    v_lshlrev_b32 v174, 16, v15
    v_and_b32 v175, 0xffff0000, v15
    v_lshlrev_b32 v176, 16, v16
    v_and_b32 v177, 0xffff0000, v16
    v_lshlrev_b32 v178, 16, v17
    v_and_b32 v179, 0xffff0000, v17
    v_lshlrev_b32 v180, 16, v18
    v_and_b32 v181, 0xffff0000, v18
    v_lshlrev_b32 v182, 16, v19
    v_and_b32 v183, 0xffff0000, v19
    v_mul_f32 v168, v168, v201
    v_mul_f32 v169, v169, v201
    v_mul_f32 v170, v170, v201
    v_mul_f32 v171, v171, v201
    v_mul_f32 v172, v172, v201
    v_mul_f32 v173, v173, v201
    v_mul_f32 v174, v174, v201
    v_mul_f32 v175, v175, v201
    v_mul_f32 v176, v176, v201
    v_mul_f32 v177, v177, v201
    v_mul_f32 v178, v178, v201
    v_mul_f32 v179, v179, v201
    v_mul_f32 v180, v180, v201
    v_mul_f32 v181, v181, v201
    v_mul_f32 v182, v182, v201
    v_mul_f32 v183, v183, v201
    v_cvt_pk_bf16_f32 v12, v168, v169
    v_cvt_pk_bf16_f32 v13, v170, v171
    v_cvt_pk_bf16_f32 v14, v172, v173
    v_cvt_pk_bf16_f32 v15, v174, v175
    v_cvt_pk_bf16_f32 v16, v176, v177
    v_cvt_pk_bf16_f32 v17, v178, v179
    v_cvt_pk_bf16_f32 v18, v180, v181
    v_cvt_pk_bf16_f32 v19, v182, v183
    s_add_u32 s28, s28, 0x9b35e3c1
    v_and_b32 v27, 1, v0
    v_lshlrev_b32 v27, 4, v27
    v_lshrrev_b32 v27, v27, s28
    v_bfe_u32 v24, v27, 0, 4
    v_bfe_u32 v25, v27, 4, 4
    v_bfe_u32 v26, v27, 8, 4
    v_bfe_u32 v27, v27, 12, 4
    v_lshrrev_b32 v2, 5, v0
    v_lshl_add_u32 v2, v2, 7, v4
    s_lshl_b32 s29, s62, 13
    s_add_u32 s29, s29, 1310720
    s_lshl_b32 s82, s34, 8
    s_lshl_b32 s83, s33, 13
    s_add_u32 s82, s82, s83
    s_add_u32 s82, s82, 1310720
    s_waitcnt vmcnt(14)
    v_perm_b32 v168, v36, v32, s69
    v_perm_b32 v169, v36, v32, s70
    v_perm_b32 v170, v37, v33, s69
    v_perm_b32 v171, v37, v33, s70
    v_perm_b32 v172, v38, v34, s69
    v_perm_b32 v173, v38, v34, s70
    v_perm_b32 v174, v39, v35, s69
    v_perm_b32 v175, v39, v35, s70
    v_dot2_f32_bf16 v160, v168, v12, 0
    v_dot2_f32_bf16 v161, v169, v12, 0
    v_dot2_f32_bf16 v162, v170, v12, 0
    v_dot2_f32_bf16 v163, v171, v12, 0
    v_dot2_f32_bf16 v164, v172, v12, 0
    v_dot2_f32_bf16 v165, v173, v12, 0
    v_dot2_f32_bf16 v166, v174, v12, 0
    v_dot2_f32_bf16 v167, v175, v12, 0
    s_waitcnt vmcnt(12)
    v_perm_b32 v168, v44, v40, s69
    v_perm_b32 v169, v44, v40, s70
    v_perm_b32 v170, v45, v41, s69
    v_perm_b32 v171, v45, v41, s70
    v_perm_b32 v172, v46, v42, s69
    v_perm_b32 v173, v46, v42, s70
    v_perm_b32 v174, v47, v43, s69
    v_perm_b32 v175, v47, v43, s70
    v_dot2_f32_bf16 v160, v168, v13, v160
    v_dot2_f32_bf16 v161, v169, v13, v161
    v_dot2_f32_bf16 v162, v170, v13, v162
    v_dot2_f32_bf16 v163, v171, v13, v163
    v_dot2_f32_bf16 v164, v172, v13, v164
    v_dot2_f32_bf16 v165, v173, v13, v165
    v_dot2_f32_bf16 v166, v174, v13, v166
    v_dot2_f32_bf16 v167, v175, v13, v167
    s_waitcnt vmcnt(10)
    v_perm_b32 v168, v52, v48, s69
    v_perm_b32 v169, v52, v48, s70
    v_perm_b32 v170, v53, v49, s69
    v_perm_b32 v171, v53, v49, s70
    v_perm_b32 v172, v54, v50, s69
    v_perm_b32 v173, v54, v50, s70
    v_perm_b32 v174, v55, v51, s69
    v_perm_b32 v175, v55, v51, s70
    v_dot2_f32_bf16 v160, v168, v14, v160
    v_dot2_f32_bf16 v161, v169, v14, v161
    v_dot2_f32_bf16 v162, v170, v14, v162
    v_dot2_f32_bf16 v163, v171, v14, v163
    v_dot2_f32_bf16 v164, v172, v14, v164
    v_dot2_f32_bf16 v165, v173, v14, v165
    v_dot2_f32_bf16 v166, v174, v14, v166
    v_dot2_f32_bf16 v167, v175, v14, v167
    s_waitcnt vmcnt(8)
    v_perm_b32 v168, v60, v56, s69
    v_perm_b32 v169, v60, v56, s70
    v_perm_b32 v170, v61, v57, s69
    v_perm_b32 v171, v61, v57, s70
    v_perm_b32 v172, v62, v58, s69
    v_perm_b32 v173, v62, v58, s70
    v_perm_b32 v174, v63, v59, s69
    v_perm_b32 v175, v63, v59, s70
    v_dot2_f32_bf16 v160, v168, v15, v160
    v_dot2_f32_bf16 v161, v169, v15, v161
    v_dot2_f32_bf16 v162, v170, v15, v162
    v_dot2_f32_bf16 v163, v171, v15, v163
    v_dot2_f32_bf16 v164, v172, v15, v164
    v_dot2_f32_bf16 v165, v173, v15, v165
    v_dot2_f32_bf16 v166, v174, v15, v166
    v_dot2_f32_bf16 v167, v175, v15, v167
    s_waitcnt vmcnt(6)
    v_perm_b32 v168, v68, v64, s69
    v_perm_b32 v169, v68, v64, s70
    v_perm_b32 v170, v69, v65, s69
    v_perm_b32 v171, v69, v65, s70
    v_perm_b32 v172, v70, v66, s69
    v_perm_b32 v173, v70, v66, s70
    v_perm_b32 v174, v71, v67, s69
    v_perm_b32 v175, v71, v67, s70
    v_dot2_f32_bf16 v160, v168, v16, v160
    v_dot2_f32_bf16 v161, v169, v16, v161
    v_dot2_f32_bf16 v162, v170, v16, v162
    v_dot2_f32_bf16 v163, v171, v16, v163
    v_dot2_f32_bf16 v164, v172, v16, v164
    v_dot2_f32_bf16 v165, v173, v16, v165
    v_dot2_f32_bf16 v166, v174, v16, v166
    v_dot2_f32_bf16 v167, v175, v16, v167
    s_waitcnt vmcnt(4)
    v_perm_b32 v168, v76, v72, s69
    v_perm_b32 v169, v76, v72, s70
    v_perm_b32 v170, v77, v73, s69
    v_perm_b32 v171, v77, v73, s70
    v_perm_b32 v172, v78, v74, s69
    v_perm_b32 v173, v78, v74, s70
    v_perm_b32 v174, v79, v75, s69
    v_perm_b32 v175, v79, v75, s70
    v_dot2_f32_bf16 v160, v168, v17, v160
    v_dot2_f32_bf16 v161, v169, v17, v161
    v_dot2_f32_bf16 v162, v170, v17, v162
    v_dot2_f32_bf16 v163, v171, v17, v163
    v_dot2_f32_bf16 v164, v172, v17, v164
    v_dot2_f32_bf16 v165, v173, v17, v165
    v_dot2_f32_bf16 v166, v174, v17, v166
    v_dot2_f32_bf16 v167, v175, v17, v167
    s_waitcnt vmcnt(2)
    v_perm_b32 v168, v84, v80, s69
    v_perm_b32 v169, v84, v80, s70
    v_perm_b32 v170, v85, v81, s69
    v_perm_b32 v171, v85, v81, s70
    v_perm_b32 v172, v86, v82, s69
    v_perm_b32 v173, v86, v82, s70
    v_perm_b32 v174, v87, v83, s69
    v_perm_b32 v175, v87, v83, s70
    v_dot2_f32_bf16 v160, v168, v18, v160
    v_dot2_f32_bf16 v161, v169, v18, v161
    v_dot2_f32_bf16 v162, v170, v18, v162
    v_dot2_f32_bf16 v163, v171, v18, v163
    v_dot2_f32_bf16 v164, v172, v18, v164
    v_dot2_f32_bf16 v165, v173, v18, v165
    v_dot2_f32_bf16 v166, v174, v18, v166
    v_dot2_f32_bf16 v167, v175, v18, v167
    s_waitcnt vmcnt(0)
    v_perm_b32 v168, v92, v88, s69
    v_perm_b32 v169, v92, v88, s70
    v_perm_b32 v170, v93, v89, s69
    v_perm_b32 v171, v93, v89, s70
    v_perm_b32 v172, v94, v90, s69
    v_perm_b32 v173, v94, v90, s70
    v_perm_b32 v174, v95, v91, s69
    v_perm_b32 v175, v95, v91, s70
    v_dot2_f32_bf16 v160, v168, v19, v160
    v_dot2_f32_bf16 v161, v169, v19, v161
    v_dot2_f32_bf16 v162, v170, v19, v162
    v_dot2_f32_bf16 v163, v171, v19, v163
    v_dot2_f32_bf16 v164, v172, v19, v164
    v_dot2_f32_bf16 v165, v173, v19, v165
    v_dot2_f32_bf16 v166, v174, v19, v166
    v_dot2_f32_bf16 v167, v175, v19, v167
    v_permlane32_swap_b32 v160, v164
    v_permlane32_swap_b32 v161, v165
    v_permlane32_swap_b32 v162, v166
    v_permlane32_swap_b32 v163, v167
    v_add_f32 v160, v160, v164
    v_add_f32 v161, v161, v165
    v_add_f32 v162, v162, v166
    v_add_f32 v163, v163, v167
    v_mov_b32 v164, v160
    v_mov_b32 v165, v161
    v_mov_b32 v166, v162
    v_mov_b32 v167, v163
    v_permlane16_swap_b32 v160, v164
    v_permlane16_swap_b32 v161, v165
    v_permlane16_swap_b32 v162, v166
    v_permlane16_swap_b32 v163, v167
    v_add_f32 v160, v160, v164
    v_add_f32 v161, v161, v165
    v_add_f32 v162, v162, v166
    v_add_f32 v163, v163, v167
    v_add_f32_dpp v160, v160, v160 row_ror:8 row_mask:0xf bank_mask:0xf
    v_add_f32_dpp v161, v161, v161 row_ror:8 row_mask:0xf bank_mask:0xf
    v_add_f32_dpp v162, v162, v162 row_ror:8 row_mask:0xf bank_mask:0xf
    v_add_f32_dpp v163, v163, v163 row_ror:8 row_mask:0xf bank_mask:0xf
    v_and_or_b32 v160, v160, -16, v24
    v_and_or_b32 v161, v161, -16, v25
    v_and_or_b32 v162, v162, -16, v26
    v_and_or_b32 v163, v163, -16, v27
    s_mov_b32 exec_lo, 0xff
    s_mov_b32 exec_hi, 0xff
    buffer_store_dwordx4 v[160:163], v2, s[12:15], s82 offen sc1
    s_mov_b64 exec, -1
    s_cmp_ge_u32 s2, 224
    s_cbranch_scc1 L_NOW1
    s_mov_b32 s4, s48
    s_mov_b32 s5, s49
    s_mov_b32 s6, 1835008
    s_mov_b32 s7, 0x20000
    s_and_b32 s81, s2, 7
    s_mul_i32 s81, s81, 229376
    s_lshr_b32 s83, s2, 3
    s_lshl_b32 s83, s83, 7
    s_add_u32 s81, s81, s83
    v_mul_u32_u24 v3, 28672, v1
    v_add_u32 v3, v3, v4
    buffer_load_dwordx4 v[96:99], v3, s[4:7], s81 offen nt
    s_addk_i32 s81, 3584
    buffer_load_dwordx4 v[100:103], v3, s[4:7], s81 offen nt
    s_addk_i32 s81, 3584
    buffer_load_dwordx4 v[104:107], v3, s[4:7], s81 offen nt
    s_addk_i32 s81, 3584
    buffer_load_dwordx4 v[108:111], v3, s[4:7], s81 offen nt
    s_addk_i32 s81, 3584
    buffer_load_dwordx4 v[112:115], v3, s[4:7], s81 offen nt
    s_addk_i32 s81, 3584
    buffer_load_dwordx4 v[116:119], v3, s[4:7], s81 offen nt
    s_addk_i32 s81, 3584
    buffer_load_dwordx4 v[120:123], v3, s[4:7], s81 offen nt
    s_addk_i32 s81, 3584
    buffer_load_dwordx4 v[124:127], v3, s[4:7], s81 offen nt
    v_lshlrev_b32 v168, 16, v20
    v_and_b32 v169, 0xffff0000, v20
    v_lshlrev_b32 v170, 16, v21
    v_and_b32 v171, 0xffff0000, v21
    v_lshlrev_b32 v172, 16, v22
    v_and_b32 v173, 0xffff0000, v22
    v_lshlrev_b32 v174, 16, v23
    v_and_b32 v175, 0xffff0000, v23
    v_sub_f32 v168, v168, v200
    v_sub_f32 v169, v169, v200
    v_sub_f32 v170, v170, v200
    v_sub_f32 v171, v171, v200
    v_sub_f32 v172, v172, v200
    v_sub_f32 v173, v173, v200
    v_sub_f32 v174, v174, v200
    v_sub_f32 v175, v175, v200
    v_cvt_pk_bf16_f32 v20, v168, v169
    v_cvt_pk_bf16_f32 v21, v170, v171
    v_cvt_pk_bf16_f32 v22, v172, v173
    v_cvt_pk_bf16_f32 v23, v174, v175
    v_lshlrev_b32 v168, 16, v20
    v_and_b32 v169, 0xffff0000, v20
    v_lshlrev_b32 v170, 16, v21
    v_and_b32 v171, 0xffff0000, v21
    v_lshlrev_b32 v172, 16, v22
    v_and_b32 v173, 0xffff0000, v22
    v_lshlrev_b32 v174, 16, v23
    v_and_b32 v175, 0xffff0000, v23
    v_mul_f32 v168, v168, v201
    v_mul_f32 v169, v169, v201
    v_mul_f32 v170, v170, v201
    v_mul_f32 v171, v171, v201
    v_mul_f32 v172, v172, v201
    v_mul_f32 v173, v173, v201
    v_mul_f32 v174, v174, v201
    v_mul_f32 v175, v175, v201
    v_cvt_pk_bf16_f32 v20, v168, v169
    v_cvt_pk_bf16_f32 v21, v170, v171
    v_cvt_pk_bf16_f32 v22, v172, v173
    v_cvt_pk_bf16_f32 v23, v174, v175
    s_lshl_b32 s82, s2, 8
    s_add_u32 s82, s82, 1376256
    s_waitcnt vmcnt(6)
    v_perm_b32 v168, v100, v96, s69
    v_perm_b32 v169, v100, v96, s70
    v_perm_b32 v170, v101, v97, s69
    v_perm_b32 v171, v101, v97, s70
    v_perm_b32 v172, v102, v98, s69
    v_perm_b32 v173, v102, v98, s70
    v_perm_b32 v174, v103, v99, s69
    v_perm_b32 v175, v103, v99, s70
    v_dot2_f32_bf16 v160, v168, v20, 0
    v_dot2_f32_bf16 v161, v169, v20, 0
    v_dot2_f32_bf16 v162, v170, v20, 0
    v_dot2_f32_bf16 v163, v171, v20, 0
    v_dot2_f32_bf16 v164, v172, v20, 0
    v_dot2_f32_bf16 v165, v173, v20, 0
    v_dot2_f32_bf16 v166, v174, v20, 0
    v_dot2_f32_bf16 v167, v175, v20, 0
    s_waitcnt vmcnt(4)
    v_perm_b32 v168, v108, v104, s69
    v_perm_b32 v169, v108, v104, s70
    v_perm_b32 v170, v109, v105, s69
    v_perm_b32 v171, v109, v105, s70
    v_perm_b32 v172, v110, v106, s69
    v_perm_b32 v173, v110, v106, s70
    v_perm_b32 v174, v111, v107, s69
    v_perm_b32 v175, v111, v107, s70
    v_dot2_f32_bf16 v160, v168, v21, v160
    v_dot2_f32_bf16 v161, v169, v21, v161
    v_dot2_f32_bf16 v162, v170, v21, v162
    v_dot2_f32_bf16 v163, v171, v21, v163
    v_dot2_f32_bf16 v164, v172, v21, v164
    v_dot2_f32_bf16 v165, v173, v21, v165
    v_dot2_f32_bf16 v166, v174, v21, v166
    v_dot2_f32_bf16 v167, v175, v21, v167
    s_waitcnt vmcnt(2)
    v_perm_b32 v168, v116, v112, s69
    v_perm_b32 v169, v116, v112, s70
    v_perm_b32 v170, v117, v113, s69
    v_perm_b32 v171, v117, v113, s70
    v_perm_b32 v172, v118, v114, s69
    v_perm_b32 v173, v118, v114, s70
    v_perm_b32 v174, v119, v115, s69
    v_perm_b32 v175, v119, v115, s70
    v_dot2_f32_bf16 v160, v168, v22, v160
    v_dot2_f32_bf16 v161, v169, v22, v161
    v_dot2_f32_bf16 v162, v170, v22, v162
    v_dot2_f32_bf16 v163, v171, v22, v163
    v_dot2_f32_bf16 v164, v172, v22, v164
    v_dot2_f32_bf16 v165, v173, v22, v165
    v_dot2_f32_bf16 v166, v174, v22, v166
    v_dot2_f32_bf16 v167, v175, v22, v167
    s_waitcnt vmcnt(0)
    v_perm_b32 v168, v124, v120, s69
    v_perm_b32 v169, v124, v120, s70
    v_perm_b32 v170, v125, v121, s69
    v_perm_b32 v171, v125, v121, s70
    v_perm_b32 v172, v126, v122, s69
    v_perm_b32 v173, v126, v122, s70
    v_perm_b32 v174, v127, v123, s69
    v_perm_b32 v175, v127, v123, s70
    v_dot2_f32_bf16 v160, v168, v23, v160
    v_dot2_f32_bf16 v161, v169, v23, v161
    v_dot2_f32_bf16 v162, v170, v23, v162
    v_dot2_f32_bf16 v163, v171, v23, v163
    v_dot2_f32_bf16 v164, v172, v23, v164
    v_dot2_f32_bf16 v165, v173, v23, v165
    v_dot2_f32_bf16 v166, v174, v23, v166
    v_dot2_f32_bf16 v167, v175, v23, v167
    v_permlane32_swap_b32 v160, v164
    v_permlane32_swap_b32 v161, v165
    v_permlane32_swap_b32 v162, v166
    v_permlane32_swap_b32 v163, v167
    v_add_f32 v160, v160, v164
    v_add_f32 v161, v161, v165
    v_add_f32 v162, v162, v166
    v_add_f32 v163, v163, v167
    v_mov_b32 v164, v160
    v_mov_b32 v165, v161
    v_mov_b32 v166, v162
    v_mov_b32 v167, v163
    v_permlane16_swap_b32 v160, v164
    v_permlane16_swap_b32 v161, v165
    v_permlane16_swap_b32 v162, v166
    v_permlane16_swap_b32 v163, v167
    v_add_f32 v160, v160, v164
    v_add_f32 v161, v161, v165
    v_add_f32 v162, v162, v166
    v_add_f32 v163, v163, v167
    v_add_f32_dpp v160, v160, v160 row_ror:8 row_mask:0xf bank_mask:0xf
    v_add_f32_dpp v161, v161, v161 row_ror:8 row_mask:0xf bank_mask:0xf
    v_add_f32_dpp v162, v162, v162 row_ror:8 row_mask:0xf bank_mask:0xf
    v_add_f32_dpp v163, v163, v163 row_ror:8 row_mask:0xf bank_mask:0xf
    v_and_or_b32 v160, v160, -16, v24
    v_and_or_b32 v161, v161, -16, v25
    v_and_or_b32 v162, v162, -16, v26
    v_and_or_b32 v163, v163, -16, v27
    s_mov_b32 exec_lo, 0xff
    s_mov_b32 exec_hi, 0xff
    buffer_store_dwordx4 v[160:163], v2, s[12:15], s82 offen sc1
    s_mov_b64 exec, -1
    s_nop 7
L_NOW1:
    v_lshlrev_b32 v3, 7, v7
    v_add_u32 v3, v3, v4
    v_bfe_u32 v6, v0, 3, 1
    v_lshl_add_u32 v3, v6, 3, v3
    v_add_u32 v3, 149760, v3
    s_branch L_H0A
L_H0:
    s_sleep 8
L_H0A:
    buffer_load_dwordx4 v[32:35], v5, s[12:15], s29 offen offset:0 sc1
    buffer_load_dwordx4 v[36:39], v5, s[12:15], s29 offen offset:1024 sc1
    buffer_load_dwordx4 v[40:43], v5, s[12:15], s29 offen offset:2048 sc1
    buffer_load_dwordx4 v[44:47], v5, s[12:15], s29 offen offset:3072 sc1
    s_add_u32 s81, s29, 4096
    buffer_load_dwordx4 v[48:51], v5, s[12:15], s81 offen offset:0 sc1
    buffer_load_dwordx4 v[52:55], v5, s[12:15], s81 offen offset:1024 sc1
    buffer_load_dwordx4 v[56:59], v5, s[12:15], s81 offen offset:2048 sc1
    buffer_load_dwordx4 v[60:63], v5, s[12:15], s81 offen offset:3072 sc1
    s_waitcnt vmcnt(0)
    v_xor_b32 v32, v24, v32
    v_xor_b32 v33, v25, v33
    v_xor_b32 v34, v26, v34
    v_xor_b32 v35, v27, v35
    v_xor_b32 v36, v24, v36
    v_xor_b32 v37, v25, v37
    v_xor_b32 v38, v26, v38
    v_xor_b32 v39, v27, v39
    v_xor_b32 v40, v24, v40
    v_xor_b32 v41, v25, v41
    v_xor_b32 v42, v26, v42
    v_xor_b32 v43, v27, v43
    v_xor_b32 v44, v24, v44
    v_xor_b32 v45, v25, v45
    v_xor_b32 v46, v26, v46
    v_xor_b32 v47, v27, v47
    v_xor_b32 v48, v24, v48
    v_xor_b32 v49, v25, v49
    v_xor_b32 v50, v26, v50
    v_xor_b32 v51, v27, v51
    v_xor_b32 v52, v24, v52
    v_xor_b32 v53, v25, v53
    v_xor_b32 v54, v26, v54
    v_xor_b32 v55, v27, v55
    v_xor_b32 v56, v24, v56
    v_xor_b32 v57, v25, v57
    v_xor_b32 v58, v26, v58
    v_xor_b32 v59, v27, v59
    v_xor_b32 v60, v24, v60
    v_xor_b32 v61, v25, v61
    v_xor_b32 v62, v26, v62
    v_xor_b32 v63, v27, v63
    v_or3_b32 v202, v32, v33, v34
    v_or3_b32 v202, v202, v35, v36
    v_or3_b32 v202, v202, v37, v38
    v_or3_b32 v202, v202, v39, v40
    v_or3_b32 v202, v202, v41, v42
    v_or3_b32 v202, v202, v43, v44
    v_or3_b32 v202, v202, v45, v46
    v_or3_b32 v202, v202, v47, v48
    v_or3_b32 v202, v202, v49, v50
    v_or3_b32 v202, v202, v51, v52
    v_or3_b32 v202, v202, v53, v54
    v_or3_b32 v202, v202, v55, v56
    v_or3_b32 v202, v202, v57, v58
    v_or3_b32 v202, v202, v59, v60
    v_or3_b32 v202, v202, v61, v62
    v_or_b32 v202, v202, v63
    v_and_b32 v202, 15, v202
    v_cmp_ne_u32 vcc, 0, v202
    s_wqm_b64 exec, vcc
    s_sub_u32 s80, s80, 1
    s_cbranch_scc1 L_EXIT
    s_cbranch_vccnz L_H0
    s_mov_b64 exec, -1
    v_add_f32 v32, v32, v48
    v_add_f32 v33, v33, v49
    v_add_f32 v34, v34, v50
    v_add_f32 v35, v35, v51
    v_add_f32 v36, v36, v52
    v_add_f32 v37, v37, v53
    v_add_f32 v38, v38, v54
    v_add_f32 v39, v39, v55
    v_add_f32 v40, v40, v56
    v_add_f32 v41, v41, v57
    v_add_f32 v42, v42, v58
    v_add_f32 v43, v43, v59
    v_add_f32 v44, v44, v60
    v_add_f32 v45, v45, v61
    v_add_f32 v46, v46, v62
    v_add_f32 v47, v47, v63
    v_add_f32 v32, v32, v40
    v_add_f32 v33, v33, v41
    v_add_f32 v34, v34, v42
    v_add_f32 v35, v35, v43
    v_add_f32 v36, v36, v44
    v_add_f32 v37, v37, v45
    v_add_f32 v38, v38, v46
    v_add_f32 v39, v39, v47
    v_cvt_pk_bf16_f32 v32, v32, v33
    v_cvt_pk_bf16_f32 v33, v34, v35
    v_cvt_pk_bf16_f32 v34, v36, v37
    v_cvt_pk_bf16_f32 v35, v38, v39
    ds_write_b64 v3, v[32:33]
    ds_write_b64 v3, v[34:35] offset:512
    s_waitcnt lgkmcnt(0)
    s_barrier
    v_and_b32 v3, 15, v0
    v_lshlrev_b32 v6, 3, v3
    v_add_u32 v6, 150784, v6
L_H2:
    s_sleep 4
    ds_read_b64 v[8:9], v6
    s_waitcnt lgkmcnt(0)
    v_max_u32 v10, v8, v9
    v_cmp_eq_u32 vcc, -1, v10
    s_sub_u32 s80, s80, 1
    s_cbranch_scc1 L_EXIT
    s_cbranch_vccnz L_H2
    v_mov_b32 v12, v8
    s_nop 1
    v_max_f32_dpp v12, v12, v12 row_ror:4 row_mask:0xf bank_mask:0xf
    s_nop 1
    v_max_f32_dpp v12, v12, v12 row_ror:8 row_mask:0xf bank_mask:0xf
    v_sub_f32 v13, v8, v12
    v_mul_f32 v13, 0x3fb8aa3b, v13
    v_exp_f32 v13, v13
    s_nop 0
    v_mul_f32 v13, v13, v9
    s_nop 1
    v_add_f32_dpp v13, v13, v13 row_ror:4 row_mask:0xf bank_mask:0xf
    s_nop 1
    v_add_f32_dpp v13, v13, v13 row_ror:8 row_mask:0xf bank_mask:0xf
    s_getreg_b32 s67, hwreg(HW_REG_XCC_ID, 0, 4)
    s_lshl_b32 s67, s67, 4
    v_mov_b32 v14, s67
    v_mov_b32 v15, 0
    v_and_or_b32 v12, v12, -16, v24
    v_and_or_b32 v13, v13, -16, v25
    v_and_or_b32 v14, v14, -16, v26
    v_and_or_b32 v15, v15, -16, v27
    s_lshl_b32 s32, s62, 12
    s_add_u32 s32, s32, 1114112
    s_lshl_b32 s81, s63, 7
    s_add_u32 s81, s81, s32
    v_lshrrev_b32 v1, 2, v0
    v_lshlrev_b32 v1, 7, v1
    v_and_b32 v2, 3, v0
    v_lshl_add_u32 v1, v2, 4, v1
    s_mov_b64 exec, 15
    buffer_store_dwordx4 v[12:15], v5, s[12:15], s81 offen sc1
    s_mov_b64 exec, -1
    s_add_u32 s33, s62, 0
    s_and_b32 s33, s33, 7
    s_mov_b32 s34, s63
    v_mov_b32 v32, 0
    v_mov_b32 v33, 0
    v_mov_b32 v34, 0
    v_mov_b32 v35, 0
    s_cmp_eq_u32 s33, 7
    s_cbranch_scc1 L_NOH
    s_mov_b32 s16, s50
    s_mov_b32 s17, s51
    s_mov_b32 s18, 3584
    s_mov_b32 s19, 0x20000
    s_lshl_b32 s81, s33, 2
    s_lshr_b32 s82, s34, 3
    s_add_u32 s81, s81, s82
    s_and_b32 s82, s34, 4
    s_lshl_b32 s29, s81, 11
    s_lshl_b32 s83, s82, 5
    s_add_u32 s29, s29, s83
    s_add_u32 s29, s29, 1376256
    s_lshl_b32 s81, s81, 7
    s_lshl_b32 s82, s82, 1
    s_add_u32 s81, s81, s82
    buffer_load_dwordx2 v[204:205], v4, s[16:19], s81 offen
    v_lshrrev_b32 v3, 3, v0
    v_lshl_add_u32 v3, v3, 8, v4
    s_branch L_H5A
L_H5:
    s_sleep 8
L_H5A:
    buffer_load_dwordx4 v[32:35], v3, s[12:15], s29 offen offset:0 sc1
    s_waitcnt vmcnt(0)
    v_xor_b32 v32, v24, v32
    v_xor_b32 v33, v25, v33
    v_xor_b32 v34, v26, v34
    v_xor_b32 v35, v27, v35
    v_or3_b32 v202, v32, v33, v34
    v_or_b32 v202, v202, v35
    v_and_b32 v202, 15, v202
    v_cmp_ne_u32 vcc, 0, v202
    s_wqm_b64 exec, vcc
    s_sub_u32 s80, s80, 1
    s_cbranch_scc1 L_EXIT
    s_cbranch_vccnz L_H5
    s_mov_b64 exec, -1
    v_add_f32_dpp v32, v32, v32 row_ror:8 row_mask:0xf bank_mask:0xf
    v_add_f32_dpp v33, v33, v33 row_ror:8 row_mask:0xf bank_mask:0xf
    v_add_f32_dpp v34, v34, v34 row_ror:8 row_mask:0xf bank_mask:0xf
    v_add_f32_dpp v35, v35, v35 row_ror:8 row_mask:0xf bank_mask:0xf
    v_mov_b32 v36, v32
    v_mov_b32 v37, v33
    v_mov_b32 v38, v34
    v_mov_b32 v39, v35
    v_permlane16_swap_b32 v32, v36
    v_permlane16_swap_b32 v33, v37
    v_permlane16_swap_b32 v34, v38
    v_permlane16_swap_b32 v35, v39
    v_add_f32 v32, v32, v36
    v_add_f32 v33, v33, v37
    v_add_f32 v34, v34, v38
    v_add_f32 v35, v35, v39
    v_mov_b32 v36, v32
    v_mov_b32 v37, v33
    v_mov_b32 v38, v34
    v_mov_b32 v39, v35
    v_permlane32_swap_b32 v32, v36
    v_permlane32_swap_b32 v33, v37
    v_permlane32_swap_b32 v34, v38
    v_permlane32_swap_b32 v35, v39
    v_add_f32 v32, v32, v36
    v_add_f32 v33, v33, v37
    v_add_f32 v34, v34, v38
    v_add_f32 v35, v35, v39
    v_cvt_pk_bf16_f32 v40, v32, v33
    v_cvt_pk_bf16_f32 v41, v34, v35
    v_lshlrev_b32 v32, 16, v40
    v_and_b32 v33, 0xffff0000, v40
    v_lshlrev_b32 v34, 16, v41
    v_and_b32 v35, 0xffff0000, v41
    v_lshlrev_b32 v36, 16, v204
    v_and_b32 v37, 0xffff0000, v204
    v_lshlrev_b32 v38, 16, v205
    v_and_b32 v39, 0xffff0000, v205
    v_add_f32 v32, v32, v36
    v_add_f32 v33, v33, v37
    v_add_f32 v34, v34, v38
    v_add_f32 v35, v35, v39
    v_cvt_pk_bf16_f32 v40, v32, v33
    v_cvt_pk_bf16_f32 v41, v34, v35
    v_lshlrev_b32 v32, 16, v40
    v_and_b32 v33, 0xffff0000, v40
    v_lshlrev_b32 v34, 16, v41
    v_and_b32 v35, 0xffff0000, v41
    v_mul_f32 v36, v32, v32
    v_mul_f32 v37, v33, v33
    v_mul_f32 v38, v34, v34
    v_mul_f32 v39, v35, v35
    v_mul_f32 v36, v36, v32
    v_mul_f32 v37, v37, v33
    v_mul_f32 v38, v38, v34
    v_mul_f32 v39, v39, v35
    v_mul_f32 v36, 0x3d372713, v36
    v_mul_f32 v37, 0x3d372713, v37
    v_mul_f32 v38, 0x3d372713, v38
    v_mul_f32 v39, 0x3d372713, v39
    v_add_f32 v36, v32, v36
    v_add_f32 v37, v33, v37
    v_add_f32 v38, v34, v38
    v_add_f32 v39, v35, v39
    v_mul_f32 v36, 0xc0135761, v36
    v_mul_f32 v37, 0xc0135761, v37
    v_mul_f32 v38, 0xc0135761, v38
    v_mul_f32 v39, 0xc0135761, v39
    v_exp_f32 v36, v36
    v_exp_f32 v37, v37
    v_exp_f32 v38, v38
    v_exp_f32 v39, v39
    v_add_f32 v36, 1.0, v36
    v_add_f32 v37, 1.0, v37
    v_add_f32 v38, 1.0, v38
    v_add_f32 v39, 1.0, v39
    v_rcp_f32 v36, v36
    v_rcp_f32 v37, v37
    v_rcp_f32 v38, v38
    v_rcp_f32 v39, v39
    v_mul_f32 v32, v32, v36
    v_mul_f32 v33, v33, v37
    v_mul_f32 v34, v34, v38
    v_mul_f32 v35, v35, v39
    v_cvt_pk_bf16_f32 v32, v32, v32
    v_cvt_pk_bf16_f32 v33, v33, v33
    v_cvt_pk_bf16_f32 v34, v34, v34
    v_cvt_pk_bf16_f32 v35, v35, v35
    s_nop 7
L_NOH:
    v_lshrrev_b32 v3, 1, v0
    v_lshlrev_b32 v3, 4, v3
    v_and_b32 v6, 1, v0
    v_lshl_add_u32 v3, v6, 1, v3
    v_add_u32 v3, 151552, v3
    s_mov_b64 exec, 0xff
    ds_write_b16 v3, v32 offset:0
    ds_write_b16 v3, v33 offset:4
    ds_write_b16 v3, v34 offset:8
    ds_write_b16 v3, v35 offset:12
    s_mov_b64 exec, -1
    s_cmp_lt_u32 s2, 224
    s_cbranch_scc1 L_NOFIN
    s_mov_b32 s4, s36
    s_mov_b32 s5, s37
    s_mov_b32 s6, 1024
    s_mov_b32 s7, 0x20000
    s_mov_b32 s8, s54
    s_mov_b32 s9, s55
    s_mov_b32 s10, 1024
    s_mov_b32 s11, 0x20000
    s_add_u32 s35, s2, 8
    s_and_b32 s35, s35, 7
    s_lshl_b32 s35, s35, 2
    s_bfe_u32 s82, s2, 0x20003
    s_add_u32 s35, s35, s82
    s_lshr_b32 s82, s35, 1
    s_lshl_b32 s82, s82, 6
    s_and_b32 s83, s35, 1
    s_lshl_b32 s83, s83, 3
    s_add_u32 s82, s82, s83
    v_and_b32 v3, 3, v0
    v_lshlrev_b32 v3, 4, v3
    v_lshl_add_u32 v3, v7, 1, v3
    buffer_load_ushort v204, v3, s[4:7], s82 offen
    buffer_load_ushort v206, v3, s[8:11], s82 offen
    v_lshlrev_b32 v3, 2, v0
    v_add_u32 v3, 151040, v3
    s_waitcnt vmcnt(0)
    v_lshlrev_b32 v206, 16, v206
    v_lshlrev_b32 v204, 16, v204
    v_add_f32 v204, v204, v206
    ds_write_b32 v3, v204
    s_nop 7
L_NOFIN:
    s_mov_b64 exec, 0
    s_branch L_IW0
L_IW15:
    s_mov_b64 exec, -1
    v_mov_b32 v6, 150912
L_H4:
    s_sleep 4
    ds_read_b32 v10, v6
    s_waitcnt lgkmcnt(0)
    v_cmp_eq_u32 vcc, -1, v10
    s_sub_u32 s80, s80, 1
    s_cbranch_scc1 L_EXIT
    s_cbranch_vccnz L_H4
    s_branch L_H3A
L_H3:
    s_sleep 8
L_H3A:
    buffer_load_dwordx4 v[12:15], v1, s[12:15], s32 offen offset:0 sc1
    buffer_load_dwordx4 v[16:19], v1, s[12:15], s32 offen offset:2048 sc1
    s_waitcnt vmcnt(0)
    v_xor_b32 v12, v24, v12
    v_xor_b32 v13, v25, v13
    v_xor_b32 v14, v26, v14
    v_xor_b32 v15, v27, v15
    v_xor_b32 v16, v24, v16
    v_xor_b32 v17, v25, v17
    v_xor_b32 v18, v26, v18
    v_xor_b32 v19, v27, v19
    v_or3_b32 v202, v12, v13, v14
    v_or3_b32 v202, v202, v15, v16
    v_or3_b32 v202, v202, v17, v18
    v_or_b32 v202, v202, v19
    v_and_b32 v202, 15, v202
    v_cmp_ne_u32 vcc, 0, v202
    s_wqm_b64 exec, vcc
    s_sub_u32 s80, s80, 1
    s_cbranch_scc1 L_EXIT
    s_cbranch_vccnz L_H3
    s_mov_b64 exec, -1
    v_xor_b32 v14, s67, v14
    v_xor_b32 v18, s67, v18
    v_or_b32 v14, v14, v18
    v_cmp_ne_u32 vcc, 0, v14
    s_nop 7
    s_cmp_eq_u64 vcc, 0
    s_cselect_b32 s67, -1, 0
    v_mov_b32 v14, s67
    v_max_f32 v10, v12, v16
    s_nop 1
    v_max_f32_dpp v10, v10, v10 row_ror:4 row_mask:0xf bank_mask:0xf
    s_nop 1
    v_max_f32_dpp v10, v10, v10 row_ror:8 row_mask:0xf bank_mask:0xf
    v_mov_b32 v11, v10
    s_nop 1
    v_permlane16_swap_b32 v11, v10
    v_max_f32 v10, v11, v10
    v_mov_b32 v11, v10
    s_nop 1
    v_permlane32_swap_b32 v11, v10
    v_max_f32 v10, v11, v10
    v_sub_f32 v12, v12, v10
    v_sub_f32 v16, v16, v10
    v_sub_f32 v8, v8, v10
    v_mul_f32 v12, 0x3fb8aa3b, v12
    v_mul_f32 v16, 0x3fb8aa3b, v16
    v_mul_f32 v8, 0x3fb8aa3b, v8
    v_exp_f32 v12, v12
    v_exp_f32 v16, v16
    v_exp_f32 v8, v8
    v_mul_f32 v12, v12, v13
    v_fmac_f32 v12, v16, v17
    s_nop 1
    v_add_f32_dpp v12, v12, v12 row_ror:4 row_mask:0xf bank_mask:0xf
    s_nop 1
    v_add_f32_dpp v12, v12, v12 row_ror:8 row_mask:0xf bank_mask:0xf
    v_mov_b32 v11, v12
    s_nop 1
    v_permlane16_swap_b32 v11, v12
    v_add_f32 v12, v11, v12
    v_mov_b32 v11, v12
    s_nop 1
    v_permlane32_swap_b32 v11, v12
    v_add_f32 v12, v11, v12
    v_rcp_f32 v12, v12
    s_nop 0
    v_mul_f32 v8, v8, v12
    v_and_b32 v6, 3, v0
    v_lshlrev_b32 v6, 4, v6
    v_and_b32 v9, 12, v0
    v_add3_u32 v6, v6, v9, 0
    v_add_u32 v6, 150976, v6
    s_mov_b64 exec, 0xffff
    ds_write_b32 v6, v8
    ds_write_b32 v6, v14 offset:640
    s_waitcnt lgkmcnt(0)
    s_branch L_EXIT
L_CTRL:
    v_lshlrev_b32 v1, 4, v0
    v_add_u32 v1, 151680, v1
    v_mov_b32 v4, 0
    v_mov_b32 v5, 0
    v_mov_b32 v6, 0
    v_mov_b32 v7, 0
    ds_write_b128 v1, v[4:7]
    ds_write_b128 v1, v[4:7] offset:1024
    s_waitcnt lgkmcnt(0)
    s_mov_b32 s12, s60
    s_mov_b32 s13, s61
    s_mov_b32 s14, 4194304
    s_mov_b32 s15, 0x20000
    s_add_u32 s30, s60, 1146880
    s_addc_u32 s31, s61, 0
    s_load_dword s28, s[30:31], 0
    s_mul_i32 s81, s62, 4224
    s_add_u32 s81, s81, 1572864
    v_lshl_add_u32 v2, v0, 2, s81
    v_mov_b32 v10, 112
    s_mov_b32 exec_lo, 0
    v_and_b32 v2, 7, v0
    v_mul_u32_u24 v2, 4224, v2
    v_add_u32 v2, 1606656, v2
    v_mov_b32 v10, 0
    s_mov_b32 exec_lo, -1
    s_lshl_b64 s[16:17], 1, s63
    s_lshl_b32 s21, 1, s62
    s_andn2_b32 s22, 0, s21
    s_lshl_b32 s81, s62, 2
    s_xor_b32 s81, s81, s63
    s_and_b32 s81, s81, 31
    s_cselect_b32 s21, 0, s21
    s_lshl_b32 s81, s63, 3
    s_add_u32 s81, s81, s62
    s_mul_i32 s81, s81, 64
    s_lshr_b32 s81, s81, 8
    s_add_u32 s26, s81, 144
    s_bitcmp0_b32 s62, 0
    s_cselect_b32 s20, 8, 5
    s_waitcnt lgkmcnt(0)
    s_add_u32 s28, s28, 0x9b35e3c1
    s_lshl_b32 s28, s28, 10
    s_movk_i32 s18, 0x400
    s_not_b32 s19, s28
    s_barrier
L_C0:
    s_sleep 2
    ds_read_b32 v3, v1
    s_sub_u32 s80, s80, 1
    s_cbranch_scc1 L_EXIT
    s_waitcnt lgkmcnt(0)
    v_readlane_b32 s8, v3, 0
    v_readlane_b32 s9, v3, 16
    v_readlane_b32 s10, v3, 32
    v_readlane_b32 s11, v3, 48
    s_add_u32 s8, s8, s9
    s_add_u32 s10, s10, s11
    s_add_u32 s8, s8, s10
    s_cmp_lt_u32 s8, s26
    s_cbranch_scc1 L_C0
    s_add_u32 s26, s26, 64
    s_or_b32 s9, s8, s28
    v_mov_b32 v9, s9
    v_mov_b32 v4, s19
    s_mov_b32 exec_hi, s22
    buffer_load_dword v4, v2, s[12:15], 0 offen nt
    s_mov_b64 exec, s[16:17]
    buffer_store_dword v9, v2, s[12:15], 0 offen
    s_mov_b64 exec, -1
    v_lshlrev_b32 v5, 2, v3
    v_add_u32 v3, s20, v3
    s_waitcnt vmcnt(1)
    v_xor_b32 v4, s28, v4
    v_cmp_gt_u32 vcc, s18, v4
    s_nop 1
    v_cndmask_b32 v4, v10, v4, vcc
    s_nop 1
    v_add_u32_dpp v4, v4, v4 row_ror:1 row_mask:0xf bank_mask:0xf
    s_nop 1
    v_add_u32_dpp v4, v4, v4 row_ror:2 row_mask:0xf bank_mask:0xf
    s_nop 1
    v_add_u32_dpp v4, v4, v4 row_ror:4 row_mask:0xf bank_mask:0xf
    s_nop 1
    v_add_u32_dpp v4, v4, v4 row_ror:8 row_mask:0xf bank_mask:0xf
    s_nop 0
    v_readlane_b32 s8, v4, 0
    v_readlane_b32 s9, v4, 16
    v_readlane_b32 s10, v4, 32
    s_add_u32 s8, s8, s9
    s_lshr_b32 s8, s8, 5
    s_add_u32 s8, s8, 32
    v_sub_u32 v5, s8, v5
    v_mul_i32_i24 v5, 3, v5
    v_ashrrev_i32 v5, 2, v5
    v_add_u32 v4, v5, v3
    v_mov_b32 v5, v4
    v_mov_b32 v6, v4
    v_mov_b32 v7, v4
    ds_write_b128 v1, v[4:7] offset:1024
    s_cmp_lt_u32 s26, 960
    s_cbranch_scc1 L_C0
    s_waitcnt lgkmcnt(0)
    s_branch L_EXIT
.section .rodata,"a"
.p2align 6
.amdhsa_kernel parallel_sum__gqa_block_cached__dense_activation_gelu__decode_kernel
  .amdhsa_next_free_vgpr 256
  .amdhsa_next_free_sgpr 102
  .amdhsa_accum_offset 256
  .amdhsa_group_segment_fixed_size 0
  .amdhsa_kernarg_size 104
  .amdhsa_user_sgpr_count 2
  .amdhsa_user_sgpr_kernarg_segment_ptr 1
  .amdhsa_system_sgpr_workgroup_id_x 1
  .amdhsa_float_denorm_mode_32 3
.end_amdhsa_kernel
```
